```python
import torch

def _softmax(x, axis=-1):
    return torch.softmax(x, dim=axis)
def _gelu(x):
    return torch.nn.functional.gelu(x, approximate="tanh")
def _silu(x):
    return torch.nn.functional.silu(x)
def _sigmoid(x):
    return torch.sigmoid(x)
def _layernorm(x, axis=-1, eps=1e-5):
    m = x.mean(dim=axis, keepdim=True)
    v = x.var(dim=axis, keepdim=True, unbiased=False)
    return (x - m) / torch.sqrt(v + eps)
def _scatter_add(tgt, idx, src, axis=0):
    return tgt.clone().index_add_(axis, idx, src)
def _segment_sum(src, seg, n):
    out = torch.zeros((n,) + src.shape[1:], dtype=src.dtype)
    return out.index_add_(0, seg, src)
def _pad(x, pw):
    flat = tuple(v for pair in reversed(pw) for v in pair)
    return torch.nn.functional.pad(x, flat)

kernel_name = 'standalone__deep_cross_wide_deep__recsys'

def setup_inputs():

    _w = (lambda a: (lambda t: t.to(torch.bfloat16) if t.is_floating_point() else t)(torch.as_tensor(a)))
    B, F, D = 1024, 100, 128
    V, Nd = min(1000, 100000), 13
    Din = F * D
    H = 4 * D
    return {
        "idx": _w((lambda lo, hi, *s: torch.randint(lo, hi, s))(0, V, B, F).to(torch.int64)),
        "table": _w((lambda *s: torch.randn(*s, dtype=torch.bfloat16) * 1.6)(V, D) * 0.05),
        "x_wide": _w((lambda *s: torch.randn(*s, dtype=torch.bfloat16) * 1.6)(B, Nd)),
        "w_wide": _w((lambda *s: torch.randn(*s, dtype=torch.bfloat16) * 1.6)(Nd) * 0.05),
        "b_wide": _w((lambda *s: torch.randn(*s, dtype=torch.bfloat16) * 1.6)(1) * 0.01),
        "W1": _w((lambda *s: torch.randn(*s, dtype=torch.bfloat16) * 1.6)(Din, H) * (2.0 / Din) ** 0.5),
        "b1": _w((lambda *s: torch.randn(*s, dtype=torch.bfloat16) * 1.6)(H) * 0.01),
        "W2": _w((lambda *s: torch.randn(*s, dtype=torch.bfloat16) * 1.6)(H) * (1.0 / H) ** 0.5),
        "b2": _w((lambda *s: torch.randn(*s, dtype=torch.bfloat16) * 1.6)(1) * 0.01),
    }

def reference(idx, table, x_wide, w_wide, b_wide, W1, b1, W2, b2):
    emb = table[idx]
    deep_in = emb.reshape(emb.shape[0], -1)
    h = deep_in @ W1 + b1
    h = h * (lambda x, dt: x.to(dt))(h > 0, h.dtype)
    deep_logit = h @ W2 + b2
    wide_logit = x_wide @ w_wide + b_wide
    return _sigmoid(wide_logit + deep_logit)
```

```asm
; @launch grid=(256,1,1) block=(256,1,1) lds=160512
.amdgcn_target "amdgcn-amd-amdhsa--gfx950"
.text
.globl standalone__deep_cross_wide_deep__recsys_kernel
.p2align 8
.type standalone__deep_cross_wide_deep__recsys_kernel,@function
standalone__deep_cross_wide_deep__recsys_kernel:
    s_cmp_ge_u32 s2, 256
    s_cbranch_scc1 L_k1_end
    s_load_dwordx4 s[4:7], s[0:1], 0
    s_load_dwordx2 s[8:9], s[0:1], 40
    s_load_dwordx2 s[10:11], s[0:1], 88
    s_load_dwordx2 s[76:77], s[0:1], 80
    s_load_dwordx4 s[80:83], s[0:1], 16
    s_load_dwordx2 s[84:85], s[0:1], 32
    s_load_dwordx4 s[88:91], s[0:1], 48
    s_load_dwordx4 s[92:95], s[0:1], 64
    s_memrealtime s[78:79]
    s_and_b32 s29, s2, 7
    s_lshr_b32 s37, s2, 3
    s_and_b32 s30, s37, 3
    s_lshr_b32 s28, s37, 2
    s_and_b32 s29, s2, 4
    s_add_u32 s29, s29, s30
    s_and_b32 s30, s2, 3
    v_and_b32 v1, 63, v0
    v_lshrrev_b32 v5, 6, v0
    s_mov_b32 s32, 80
    v_readfirstlane_b32 s31, v5
    s_mov_b32 s33, 0x05040100
    s_mov_b32 s34, 0x07060302
    s_mov_b32 s35, 4096
    s_mul_i32 s37, s28, 51200
    s_lshl_b32 s38, s31, 10
    s_add_u32 s37, s37, s38
    v_lshlrev_b32 v5, 4, v1
    v_add_u32 v12, s37, v5
    s_lshl_b32 s37, s31, 17
    s_lshl_b32 s38, s30, 15
    s_add_u32 s37, s37, s38
    s_lshl_b32 s38, s29, 7
    s_add_u32 s37, s37, s38
    v_lshrrev_b32 v5, 4, v1
    v_lshlrev_b32 v4, 4, v5
    v_lshlrev_b32 v5, 13, v5
    v_and_b32 v6, 15, v1
    v_lshl_add_u32 v5, v6, 2, v5
    v_add_u32 v2, s37, v5
    s_lshl_b32 s39, s31, 10
    s_waitcnt lgkmcnt(0)
    s_mov_b32 s12, s4
    s_and_b32 s13, s5, 0xffff
    s_mov_b32 s14, 409600
    s_mov_b32 s15, 0x20000
    s_mov_b32 s20, s8
    s_and_b32 s21, s9, 0xffff
    s_mov_b32 s22, 13107200
    s_mov_b32 s23, 0x20000
    s_or_b32 s40, s2, s31
    s_cmp_lg_u32 s40, 0
    s_cbranch_scc1 L_nononce
    s_or_b32 s40, s78, 1
    s_mul_i32 s40, s40, 0x9E3779B1
    v_mov_b32 v10, 0
    v_mov_b32 v11, s40
    s_mov_b64 exec, 1
    global_store_dword v10, v11, s[76:77] sc1
    s_mov_b64 exec, -1
L_nononce:
    s_lshr_b32 s40, s2, 3
    s_and_b32 s40, s40, 3
    s_mul_i32 s40, s40, 12288
    s_add_u32 s39, s39, 80640
    s_add_u32 m0, s39, s40
    v_add_u32 v11, s40, v12
    buffer_load_dwordx4 v11, s[12:15], 0 offen lds
    s_add_u32 s40, s40, 4096
    s_cmp_eq_u32 s40, 53248
    s_cselect_b32 s40, 0, s40
    s_add_u32 m0, s39, s40
    v_add_u32 v11, s40, v12
    buffer_load_dwordx4 v11, s[12:15], 0 offen lds
    s_add_u32 s40, s40, 4096
    s_cmp_eq_u32 s40, 53248
    s_cselect_b32 s40, 0, s40
    s_add_u32 m0, s39, s40
    v_add_u32 v11, s40, v12
    buffer_load_dwordx4 v11, s[12:15], 0 offen lds
    s_add_u32 s40, s40, 4096
    s_cmp_eq_u32 s40, 53248
    s_cselect_b32 s40, 0, s40
    s_add_u32 m0, s39, s40
    v_add_u32 v11, s40, v12
    buffer_load_dwordx4 v11, s[12:15], 0 offen lds
    s_add_u32 s40, s40, 4096
    s_cmp_eq_u32 s40, 53248
    s_cselect_b32 s40, 0, s40
    s_add_u32 m0, s39, s40
    v_add_u32 v11, s40, v12
    buffer_load_dwordx4 v11, s[12:15], 0 offen lds
    s_add_u32 s40, s40, 4096
    s_cmp_eq_u32 s40, 53248
    s_cselect_b32 s40, 0, s40
    s_add_u32 m0, s39, s40
    v_add_u32 v11, s40, v12
    buffer_load_dwordx4 v11, s[12:15], 0 offen lds
    s_add_u32 s40, s40, 4096
    s_cmp_eq_u32 s40, 53248
    s_cselect_b32 s40, 0, s40
    s_add_u32 m0, s39, s40
    v_add_u32 v11, s40, v12
    buffer_load_dwordx4 v11, s[12:15], 0 offen lds
    s_add_u32 s40, s40, 4096
    s_cmp_eq_u32 s40, 53248
    s_cselect_b32 s40, 0, s40
    s_add_u32 m0, s39, s40
    v_add_u32 v11, s40, v12
    buffer_load_dwordx4 v11, s[12:15], 0 offen lds
    s_add_u32 s40, s40, 4096
    s_cmp_eq_u32 s40, 53248
    s_cselect_b32 s40, 0, s40
    s_add_u32 m0, s39, s40
    v_add_u32 v11, s40, v12
    buffer_load_dwordx4 v11, s[12:15], 0 offen lds
    s_add_u32 s40, s40, 4096
    s_cmp_eq_u32 s40, 53248
    s_cselect_b32 s40, 0, s40
    s_add_u32 m0, s39, s40
    v_add_u32 v11, s40, v12
    buffer_load_dwordx4 v11, s[12:15], 0 offen lds
    s_add_u32 s40, s40, 4096
    s_cmp_eq_u32 s40, 53248
    s_cselect_b32 s40, 0, s40
    s_add_u32 m0, s39, s40
    v_add_u32 v11, s40, v12
    buffer_load_dwordx4 v11, s[12:15], 0 offen lds
    s_add_u32 s40, s40, 4096
    s_cmp_eq_u32 s40, 53248
    s_cselect_b32 s40, 0, s40
    s_add_u32 m0, s39, s40
    v_add_u32 v11, s40, v12
    buffer_load_dwordx4 v11, s[12:15], 0 offen lds
    s_add_u32 s40, s40, 4096
    s_cmp_eq_u32 s40, 53248
    s_cselect_b32 s40, 0, s40
    s_add_u32 m0, s39, s40
    v_add_u32 v11, s40, v12
    buffer_load_dwordx4 v11, s[12:15], 0 offen lds
    s_mov_b32 s16, s6
    s_and_b32 s17, s7, 0xffff
    s_mov_b32 s18, 256000
    s_mov_b32 s19, 0x20000
    s_mov_b32 s24, s10
    s_and_b32 s25, s11, 0xffff
    s_mov_b32 s26, 8388608
    s_mov_b32 s27, 0x20000
    buffer_load_dword v156, v2, s[20:23], 0 offen offset:0
    buffer_load_dword v157, v2, s[20:23], 0 offen offset:64
    buffer_load_dword v158, v2, s[20:23], 0 offen offset:1024
    buffer_load_dword v159, v2, s[20:23], 0 offen offset:1088
    buffer_load_dword v160, v2, s[20:23], 0 offen offset:2048
    buffer_load_dword v161, v2, s[20:23], 0 offen offset:2112
    buffer_load_dword v162, v2, s[20:23], 0 offen offset:3072
    buffer_load_dword v163, v2, s[20:23], 0 offen offset:3136
    buffer_load_dword v164, v2, s[20:23], s35 offen offset:0
    buffer_load_dword v165, v2, s[20:23], s35 offen offset:64
    buffer_load_dword v166, v2, s[20:23], s35 offen offset:1024
    buffer_load_dword v167, v2, s[20:23], s35 offen offset:1088
    buffer_load_dword v168, v2, s[20:23], s35 offen offset:2048
    buffer_load_dword v169, v2, s[20:23], s35 offen offset:2112
    buffer_load_dword v170, v2, s[20:23], s35 offen offset:3072
    buffer_load_dword v171, v2, s[20:23], s35 offen offset:3136
    v_add_u32 v2, 0x80000, v2
    v_mul_u32_u24 v5, 205, v1
    v_lshrrev_b32 v5, 10, v5
    v_mul_u32_u24 v6, 5, v5
    v_sub_u32 v6, v1, v6
    v_lshlrev_b32 v5, 8, v5
    v_lshl_add_u32 v5, v6, 4, v5
    s_mul_i32 s37, s31, 3072
    s_lshl_b32 s38, s30, 6
    s_add_u32 s37, s37, s38
    v_add_u32 v13, s37, v5
    s_mul_i32 s39, s31, 960
    s_mov_b32 s40, 0xdef7bdef
    s_mov_b32 s41, 0x07bdef7b
    s_lshr_b32 s98, s2, 3
    s_mul_i32 s98, s98, 21
    s_lshr_b32 s98, s98, 5
    s_mul_i32 s99, s98, 12288
    s_mul_i32 s98, s98, 3840
    v_add_u32 v11, s99, v13
    s_add_u32 m0, s39, s98
    s_mov_b64 exec, s[40:41]
    buffer_load_dwordx4 v11, s[16:19], 0 offen lds
    s_mov_b64 exec, -1
    s_add_u32 s98, s98, 3840
    s_add_u32 s99, s99, 12288
    s_cmp_eq_u32 s98, 80640
    s_cselect_b32 s98, 0, s98
    s_cselect_b32 s99, 0, s99
    v_add_u32 v11, s99, v13
    s_add_u32 m0, s39, s98
    s_mov_b64 exec, s[40:41]
    buffer_load_dwordx4 v11, s[16:19], 0 offen lds
    s_mov_b64 exec, -1
    s_add_u32 s98, s98, 3840
    s_add_u32 s99, s99, 12288
    s_cmp_eq_u32 s98, 80640
    s_cselect_b32 s98, 0, s98
    s_cselect_b32 s99, 0, s99
    v_add_u32 v11, s99, v13
    s_add_u32 m0, s39, s98
    s_mov_b64 exec, s[40:41]
    buffer_load_dwordx4 v11, s[16:19], 0 offen lds
    s_mov_b64 exec, -1
    s_add_u32 s98, s98, 3840
    s_add_u32 s99, s99, 12288
    s_cmp_eq_u32 s98, 80640
    s_cselect_b32 s98, 0, s98
    s_cselect_b32 s99, 0, s99
    v_add_u32 v11, s99, v13
    s_add_u32 m0, s39, s98
    s_mov_b64 exec, s[40:41]
    buffer_load_dwordx4 v11, s[16:19], 0 offen lds
    s_mov_b64 exec, -1
    s_add_u32 s98, s98, 3840
    s_add_u32 s99, s99, 12288
    s_cmp_eq_u32 s98, 80640
    s_cselect_b32 s98, 0, s98
    s_cselect_b32 s99, 0, s99
    s_lshl_b32 s37, s31, 8
    s_add_u32 s37, s37, 131840
    v_and_b32 v5, 15, v1
    v_lshlrev_b32 v6, 4, v5
    v_add_u32 v3, s37, v6
    v_lshrrev_b32 v6, 4, v1
    v_mul_u32_u24 v7, 400, v5
    v_lshl_add_u32 v7, v6, 4, v7
    s_lshl_b32 s37, s31, 6
    s_add_u32 s37, s37, 80640
    v_add_u32 v14, s37, v7
    v_lshlrev_b32 v7, 10, v6
    v_lshl_add_u32 v7, v5, 4, v7
    s_lshl_b32 s37, s31, 12
    s_add_u32 s37, s37, 131840
    v_add_u32 v15, s37, v7
    v_lshlrev_b32 v8, 4, v1
    s_add_u32 s37, s31, 1
    s_and_b32 s37, s37, 3
    s_lshl_b32 s37, s37, 13
    s_add_u32 s37, s37, 80640
    v_add_u32 v236, s37, v8
    s_add_u32 s37, s31, 2
    s_and_b32 s37, s37, 3
    s_lshl_b32 s37, s37, 14
    s_add_u32 s37, s37, 0
    v_add_u32 v237, s37, v8
    s_add_u32 s37, s31, 3
    s_and_b32 s37, s37, 3
    s_lshl_b32 s37, s37, 14
    s_add_u32 s37, s37, 8192
    v_add_u32 v238, s37, v8
    s_lshl_b32 s37, s31, 14
    v_add_u32 v239, s37, v8
    s_lshl_b32 s37, s31, 13
    s_add_u32 s37, s37, 80640
    v_add_u32 v243, s37, v8
    v_and_b32 v8, 15, v1
    v_lshrrev_b32 v9, 2, v8
    v_lshlrev_b32 v9, 8, v9
    v_and_b32 v10, 3, v1
    v_lshl_add_u32 v9, v10, 4, v9
    v_lshl_add_u32 v9, v4, 2, v9
    s_lshl_b32 s37, s28, 3
    s_lshl_b32 s38, s31, 1
    s_add_u32 s37, s37, s38
    s_lshl_b32 s37, s37, 3
    s_add_u32 s37, s37, s29
    s_lshl_b32 s37, s37, 11
    s_lshl_b32 s38, s30, 20
    s_add_u32 s37, s37, s38
    v_add_u32 v240, s37, v9
    s_lshl_b32 s37, s28, 3
    s_add_u32 s37, s37, s29
    s_lshl_b32 s38, s37, 14
    s_lshl_b32 s43, s30, 8
    s_add_u32 s38, s38, s43
    s_lshl_b32 s43, s31, 12
    s_add_u32 s38, s38, s43
    v_lshlrev_b32 v241, 6, v4
    v_lshl_add_u32 v241, v8, 4, v241
    v_add_u32 v241, s38, v241
    s_lshl_b32 s42, s37, 4
    s_lshl_b32 s43, s30, 2
    s_add_u32 s42, s42, s43
    v_lshrrev_b32 v9, 2, v1
    v_lshlrev_b32 v242, 4, v9
    s_lshl_b32 s43, s31, 8
    v_add_u32 v242, s43, v242
    v_add_u32 v9, s42, v10
    v_mul_u32_u24 v9, 13, v9
    v_lshrrev_b32 v8, 2, v1
    v_add_u32 v9, v9, v8
    v_lshlrev_b32 v244, 1, v9
    v_lshlrev_b32 v245, 1, v8
    s_cmp_eq_u32 s31, 0
    s_cselect_b32 s43, 13, 0
    v_cmp_gt_u32 vcc, s43, v8
    v_mov_b32 v9, 0x7fffffff
    s_nop 1
    v_cndmask_b32 v244, v9, v244, vcc
    v_cndmask_b32 v245, v9, v245, vcc
    v_lshrrev_b32 v9, 4, v1
    v_lshl_add_u32 v9, v10, 4, v9
    s_lshl_b32 s43, s31, 2
    v_add_u32 v9, s43, v9
    v_lshlrev_b32 v9, 2, v9
    v_add_u32 v246, 120000, v9
    v_lshlrev_b32 v247, 6, v0
    v_add_u32 v247, 120000, v247
    s_mul_i32 s37, s28, 4096
    s_add_u32 s37, s37, 8388608
    s_lshl_b32 s38, s29, 2
    s_add_u32 s38, s38, s30
    s_lshl_b32 s43, s38, 2
    s_add_u32 s43, s43, s37
    v_lshlrev_b32 v248, 8, v1
    v_add_u32 v248, s43, v248
    s_and_b32 s38, s38, 15
    s_lshl_b32 s38, s38, 8
    s_add_u32 s37, s37, s38
    v_and_b32 v9, 31, v1
    v_lshlrev_b32 v9, 2, v9
    v_add_u32 v249, s37, v9
    v_add_u32 v11, s99, v13
    s_add_u32 m0, s39, s98
    s_mov_b64 exec, s[40:41]
    buffer_load_dwordx4 v11, s[16:19], 0 offen lds
    s_mov_b64 exec, -1
    s_add_u32 s98, s98, 3840
    s_add_u32 s99, s99, 12288
    s_cmp_eq_u32 s98, 80640
    s_cselect_b32 s98, 0, s98
    s_cselect_b32 s99, 0, s99
    v_mov_b32 v44, 0
    v_mov_b32 v45, 0
    v_mov_b32 v46, 0
    v_mov_b32 v47, 0
    v_mov_b32 v48, 0
    v_mov_b32 v49, 0
    v_mov_b32 v50, 0
    v_mov_b32 v51, 0
    v_mov_b32 v52, 0
    v_mov_b32 v53, 0
    v_mov_b32 v54, 0
    v_mov_b32 v55, 0
    v_mov_b32 v56, 0
    v_mov_b32 v57, 0
    v_mov_b32 v58, 0
    v_mov_b32 v59, 0
    v_mov_b32 v60, 0
    v_mov_b32 v61, 0
    v_mov_b32 v62, 0
    v_mov_b32 v63, 0
    v_mov_b32 v64, 0
    v_mov_b32 v65, 0
    v_mov_b32 v66, 0
    v_mov_b32 v67, 0
    v_mov_b32 v68, 0
    v_mov_b32 v69, 0
    v_mov_b32 v70, 0
    v_mov_b32 v71, 0
    v_mov_b32 v72, 0
    v_mov_b32 v73, 0
    v_mov_b32 v74, 0
    v_mov_b32 v75, 0
    v_add_u32 v11, s99, v13
    s_add_u32 m0, s39, s98
    s_mov_b64 exec, s[40:41]
    buffer_load_dwordx4 v11, s[16:19], 0 offen lds
    s_mov_b64 exec, -1
    s_add_u32 s98, s98, 3840
    s_add_u32 s99, s99, 12288
    s_cmp_eq_u32 s98, 80640
    s_cselect_b32 s98, 0, s98
    s_cselect_b32 s99, 0, s99
    v_accvgpr_write_b32 a0, 0
    v_accvgpr_write_b32 a1, 0
    v_accvgpr_write_b32 a2, 0
    v_accvgpr_write_b32 a3, 0
    v_accvgpr_write_b32 a4, 0
    v_accvgpr_write_b32 a5, 0
    v_accvgpr_write_b32 a6, 0
    v_accvgpr_write_b32 a7, 0
    v_accvgpr_write_b32 a8, 0
    v_accvgpr_write_b32 a9, 0
    v_accvgpr_write_b32 a10, 0
    v_accvgpr_write_b32 a11, 0
    v_accvgpr_write_b32 a12, 0
    v_accvgpr_write_b32 a13, 0
    v_accvgpr_write_b32 a14, 0
    v_accvgpr_write_b32 a15, 0
    v_accvgpr_write_b32 a16, 0
    v_accvgpr_write_b32 a17, 0
    v_accvgpr_write_b32 a18, 0
    v_accvgpr_write_b32 a19, 0
    v_accvgpr_write_b32 a20, 0
    v_accvgpr_write_b32 a21, 0
    v_accvgpr_write_b32 a22, 0
    v_accvgpr_write_b32 a23, 0
    v_accvgpr_write_b32 a24, 0
    v_accvgpr_write_b32 a25, 0
    v_accvgpr_write_b32 a26, 0
    v_accvgpr_write_b32 a27, 0
    v_accvgpr_write_b32 a28, 0
    v_accvgpr_write_b32 a29, 0
    v_accvgpr_write_b32 a30, 0
    v_accvgpr_write_b32 a31, 0
    v_add_u32 v11, s99, v13
    s_add_u32 m0, s39, s98
    s_mov_b64 exec, s[40:41]
    buffer_load_dwordx4 v11, s[16:19], 0 offen lds
    s_mov_b64 exec, -1
    s_add_u32 s98, s98, 3840
    s_add_u32 s99, s99, 12288
    s_cmp_eq_u32 s98, 80640
    s_cselect_b32 s98, 0, s98
    s_cselect_b32 s99, 0, s99
    v_accvgpr_write_b32 a32, 0
    v_accvgpr_write_b32 a33, 0
    v_accvgpr_write_b32 a34, 0
    v_accvgpr_write_b32 a35, 0
    v_accvgpr_write_b32 a36, 0
    v_accvgpr_write_b32 a37, 0
    v_accvgpr_write_b32 a38, 0
    v_accvgpr_write_b32 a39, 0
    v_accvgpr_write_b32 a40, 0
    v_accvgpr_write_b32 a41, 0
    v_accvgpr_write_b32 a42, 0
    v_accvgpr_write_b32 a43, 0
    v_accvgpr_write_b32 a44, 0
    v_accvgpr_write_b32 a45, 0
    v_accvgpr_write_b32 a46, 0
    v_accvgpr_write_b32 a47, 0
    v_accvgpr_write_b32 a48, 0
    v_accvgpr_write_b32 a49, 0
    v_accvgpr_write_b32 a50, 0
    v_accvgpr_write_b32 a51, 0
    v_accvgpr_write_b32 a52, 0
    v_accvgpr_write_b32 a53, 0
    v_accvgpr_write_b32 a54, 0
    v_accvgpr_write_b32 a55, 0
    v_accvgpr_write_b32 a56, 0
    v_accvgpr_write_b32 a57, 0
    v_accvgpr_write_b32 a58, 0
    v_accvgpr_write_b32 a59, 0
    v_accvgpr_write_b32 a60, 0
    v_accvgpr_write_b32 a61, 0
    v_accvgpr_write_b32 a62, 0
    v_accvgpr_write_b32 a63, 0
    v_add_u32 v11, s99, v13
    s_add_u32 m0, s39, s98
    s_mov_b64 exec, s[40:41]
    buffer_load_dwordx4 v11, s[16:19], 0 offen lds
    s_mov_b64 exec, -1
    s_add_u32 s98, s98, 3840
    s_add_u32 s99, s99, 12288
    s_cmp_eq_u32 s98, 80640
    s_cselect_b32 s98, 0, s98
    s_cselect_b32 s99, 0, s99
    v_accvgpr_write_b32 a64, 0
    v_accvgpr_write_b32 a65, 0
    v_accvgpr_write_b32 a66, 0
    v_accvgpr_write_b32 a67, 0
    v_accvgpr_write_b32 a68, 0
    v_accvgpr_write_b32 a69, 0
    v_accvgpr_write_b32 a70, 0
    v_accvgpr_write_b32 a71, 0
    v_accvgpr_write_b32 a72, 0
    v_accvgpr_write_b32 a73, 0
    v_accvgpr_write_b32 a74, 0
    v_accvgpr_write_b32 a75, 0
    v_accvgpr_write_b32 a76, 0
    v_accvgpr_write_b32 a77, 0
    v_accvgpr_write_b32 a78, 0
    v_accvgpr_write_b32 a79, 0
    v_accvgpr_write_b32 a80, 0
    v_accvgpr_write_b32 a81, 0
    v_accvgpr_write_b32 a82, 0
    v_accvgpr_write_b32 a83, 0
    v_accvgpr_write_b32 a84, 0
    v_accvgpr_write_b32 a85, 0
    v_accvgpr_write_b32 a86, 0
    v_accvgpr_write_b32 a87, 0
    v_accvgpr_write_b32 a88, 0
    v_accvgpr_write_b32 a89, 0
    v_accvgpr_write_b32 a90, 0
    v_accvgpr_write_b32 a91, 0
    v_accvgpr_write_b32 a92, 0
    v_accvgpr_write_b32 a93, 0
    v_accvgpr_write_b32 a94, 0
    v_accvgpr_write_b32 a95, 0
    s_waitcnt vmcnt(24)
    s_barrier
    v_add_u32 v11, s99, v13
    s_add_u32 m0, s39, s98
    s_mov_b64 exec, s[40:41]
    buffer_load_dwordx4 v11, s[16:19], 0 offen lds
    s_mov_b64 exec, -1
    s_add_u32 s98, s98, 3840
    s_add_u32 s99, s99, 12288
    s_cmp_eq_u32 s98, 80640
    s_cselect_b32 s98, 0, s98
    s_cselect_b32 s99, 0, s99
    ds_read_b128 v[92:95], v14 offset:0
    ds_read_b128 v[96:99], v14 offset:6400
    ds_read_b128 v[100:103], v14 offset:12800
    ds_read_b128 v[104:107], v14 offset:19200
    v_add_u32 v11, s99, v13
    s_add_u32 m0, s39, s98
    s_mov_b64 exec, s[40:41]
    buffer_load_dwordx4 v11, s[16:19], 0 offen lds
    s_mov_b64 exec, -1
    s_add_u32 s98, s98, 3840
    s_add_u32 s99, s99, 12288
    s_cmp_eq_u32 s98, 80640
    s_cselect_b32 s98, 0, s98
    s_cselect_b32 s99, 0, s99
    ds_read_b128 v[108:111], v14 offset:25600
    ds_read_b128 v[112:115], v14 offset:32000
    ds_read_b128 v[116:119], v14 offset:38400
    ds_read_b128 v[120:123], v14 offset:44800
    v_add_u32 v11, s99, v13
    s_add_u32 m0, s39, s98
    s_mov_b64 exec, s[40:41]
    buffer_load_dwordx4 v11, s[16:19], 0 offen lds
    s_mov_b64 exec, -1
    s_add_u32 s98, s98, 3840
    s_add_u32 s99, s99, 12288
    s_cmp_eq_u32 s98, 80640
    s_cselect_b32 s98, 0, s98
    s_cselect_b32 s99, 0, s99
    ds_read_b128 v[124:127], v14 offset:256
    ds_read_b128 v[128:131], v14 offset:6656
    ds_read_b128 v[132:135], v14 offset:13056
    ds_read_b128 v[136:139], v14 offset:19456
    v_add_u32 v11, s99, v13
    s_add_u32 m0, s39, s98
    s_mov_b64 exec, s[40:41]
    buffer_load_dwordx4 v11, s[16:19], 0 offen lds
    s_mov_b64 exec, -1
    s_add_u32 s98, s98, 3840
    s_add_u32 s99, s99, 12288
    s_cmp_eq_u32 s98, 80640
    s_cselect_b32 s98, 0, s98
    s_cselect_b32 s99, 0, s99
    ds_read_b128 v[140:143], v14 offset:25856
    ds_read_b128 v[144:147], v14 offset:32256
    ds_read_b128 v[148:151], v14 offset:38656
    ds_read_b128 v[152:155], v14 offset:45056
    v_add_u32 v11, s99, v13
    s_add_u32 m0, s39, s98
    s_mov_b64 exec, s[40:41]
    buffer_load_dwordx4 v11, s[16:19], 0 offen lds
    s_mov_b64 exec, -1
    s_add_u32 s98, s98, 3840
    s_add_u32 s99, s99, 12288
    s_cmp_eq_u32 s98, 80640
    s_cselect_b32 s98, 0, s98
    s_cselect_b32 s99, 0, s99
    s_waitcnt lgkmcnt(8)
    v_lshl_or_b32 v16, v96, 16, v92
    v_lshl_or_b32 v17, v104, 16, v100
    v_lshl_or_b32 v18, v112, 16, v108
    v_add_u32 v11, s99, v13
    s_add_u32 m0, s39, s98
    s_mov_b64 exec, s[40:41]
    buffer_load_dwordx4 v11, s[16:19], 0 offen lds
    s_mov_b64 exec, -1
    s_add_u32 s98, s98, 3840
    s_add_u32 s99, s99, 12288
    s_cmp_eq_u32 s98, 80640
    s_cselect_b32 s98, 0, s98
    s_cselect_b32 s99, 0, s99
    v_lshl_or_b32 v19, v120, 16, v116
    ds_write_b128 v15, v[16:19] offset:0
    v_lshl_or_b32 v20, v105, 16, v101
    v_lshl_or_b32 v21, v113, 16, v109
    v_add_u32 v11, s99, v13
    s_add_u32 m0, s39, s98
    s_mov_b64 exec, s[40:41]
    buffer_load_dwordx4 v11, s[16:19], 0 offen lds
    s_mov_b64 exec, -1
    s_add_u32 s98, s98, 3840
    s_add_u32 s99, s99, 12288
    s_cmp_eq_u32 s98, 80640
    s_cselect_b32 s98, 0, s98
    s_cselect_b32 s99, 0, s99
    v_lshl_or_b32 v22, v121, 16, v117
    v_lshl_or_b32 v23, v97, 16, v93
    ds_write_b128 v15, v[20:23] offset:256
    v_lshl_or_b32 v16, v114, 16, v110
    v_add_u32 v11, s99, v13
    s_add_u32 m0, s39, s98
    s_mov_b64 exec, s[40:41]
    buffer_load_dwordx4 v11, s[16:19], 0 offen lds
    s_mov_b64 exec, -1
    s_add_u32 s98, s98, 3840
    s_add_u32 s99, s99, 12288
    s_cmp_eq_u32 s98, 80640
    s_cselect_b32 s98, 0, s98
    s_cselect_b32 s99, 0, s99
    v_lshl_or_b32 v17, v122, 16, v118
    v_lshl_or_b32 v18, v98, 16, v94
    v_lshl_or_b32 v19, v106, 16, v102
    ds_write_b128 v15, v[16:19] offset:512
    v_add_u32 v11, s99, v13
    s_add_u32 m0, s39, s98
    s_mov_b64 exec, s[40:41]
    buffer_load_dwordx4 v11, s[16:19], 0 offen lds
    s_mov_b64 exec, -1
    s_add_u32 s98, s98, 3840
    s_add_u32 s99, s99, 12288
    s_cmp_eq_u32 s98, 80640
    s_cselect_b32 s98, 0, s98
    s_cselect_b32 s99, 0, s99
    v_lshl_or_b32 v20, v123, 16, v119
    v_lshl_or_b32 v21, v99, 16, v95
    v_lshl_or_b32 v22, v107, 16, v103
    v_lshl_or_b32 v23, v115, 16, v111
    v_add_u32 v11, s99, v13
    s_add_u32 m0, s39, s98
    s_mov_b64 exec, s[40:41]
    buffer_load_dwordx4 v11, s[16:19], 0 offen lds
    s_mov_b64 exec, -1
    s_add_u32 s98, s98, 3840
    s_add_u32 s99, s99, 12288
    s_cmp_eq_u32 s98, 80640
    s_cselect_b32 s98, 0, s98
    s_cselect_b32 s99, 0, s99
    ds_write_b128 v15, v[20:23] offset:768
    s_waitcnt lgkmcnt(4)
    v_lshl_or_b32 v16, v128, 16, v124
    v_lshl_or_b32 v17, v136, 16, v132
    v_add_u32 v11, s99, v13
    s_add_u32 m0, s39, s98
    s_mov_b64 exec, s[40:41]
    buffer_load_dwordx4 v11, s[16:19], 0 offen lds
    s_mov_b64 exec, -1
    s_add_u32 s98, s98, 3840
    s_add_u32 s99, s99, 12288
    s_cmp_eq_u32 s98, 80640
    s_cselect_b32 s98, 0, s98
    s_cselect_b32 s99, 0, s99
    v_lshl_or_b32 v18, v144, 16, v140
    v_lshl_or_b32 v19, v152, 16, v148
    ds_write_b128 v15, v[16:19] offset:16384
    v_lshl_or_b32 v20, v137, 16, v133
    v_add_u32 v11, s99, v13
    s_add_u32 m0, s39, s98
    s_mov_b64 exec, s[40:41]
    buffer_load_dwordx4 v11, s[16:19], 0 offen lds
    s_mov_b64 exec, -1
    s_add_u32 s98, s98, 3840
    s_add_u32 s99, s99, 12288
    s_cmp_eq_u32 s98, 80640
    s_cselect_b32 s98, 0, s98
    s_cselect_b32 s99, 0, s99
    v_lshl_or_b32 v21, v145, 16, v141
    v_lshl_or_b32 v22, v153, 16, v149
    v_lshl_or_b32 v23, v129, 16, v125
    ds_write_b128 v15, v[20:23] offset:16640
    v_add_u32 v11, s99, v13
    s_add_u32 m0, s39, s98
    s_mov_b64 exec, s[40:41]
    buffer_load_dwordx4 v11, s[16:19], 0 offen lds
    s_mov_b64 exec, -1
    s_add_u32 s98, s98, 3840
    s_add_u32 s99, s99, 12288
    s_cmp_eq_u32 s98, 80640
    s_cselect_b32 s98, 0, s98
    s_cselect_b32 s99, 0, s99
    v_lshl_or_b32 v16, v146, 16, v142
    v_lshl_or_b32 v17, v154, 16, v150
    v_lshl_or_b32 v18, v130, 16, v126
    v_lshl_or_b32 v19, v138, 16, v134
    ds_write_b128 v15, v[16:19] offset:16896
    v_lshl_or_b32 v20, v155, 16, v151
    v_lshl_or_b32 v21, v131, 16, v127
    v_lshl_or_b32 v22, v139, 16, v135
    v_lshl_or_b32 v23, v147, 16, v143
    ds_write_b128 v15, v[20:23] offset:17152
    buffer_load_dword v172, v2, s[20:23], 0 offen offset:0
    buffer_load_dword v173, v2, s[20:23], 0 offen offset:64
    buffer_load_dword v174, v2, s[20:23], 0 offen offset:1024
    buffer_load_dword v175, v2, s[20:23], 0 offen offset:1088
    buffer_load_dword v176, v2, s[20:23], 0 offen offset:2048
    buffer_load_dword v177, v2, s[20:23], 0 offen offset:2112
    buffer_load_dword v178, v2, s[20:23], 0 offen offset:3072
    buffer_load_dword v179, v2, s[20:23], 0 offen offset:3136
    buffer_load_dword v180, v2, s[20:23], s35 offen offset:0
    buffer_load_dword v181, v2, s[20:23], s35 offen offset:64
    buffer_load_dword v182, v2, s[20:23], s35 offen offset:1024
    buffer_load_dword v183, v2, s[20:23], s35 offen offset:1088
    buffer_load_dword v184, v2, s[20:23], s35 offen offset:2048
    buffer_load_dword v185, v2, s[20:23], s35 offen offset:2112
    buffer_load_dword v186, v2, s[20:23], s35 offen offset:3072
    buffer_load_dword v187, v2, s[20:23], s35 offen offset:3136
    v_add_u32 v2, 0x80000, v2
    buffer_load_dword v188, v2, s[20:23], 0 offen offset:0
    buffer_load_dword v189, v2, s[20:23], 0 offen offset:64
    buffer_load_dword v190, v2, s[20:23], 0 offen offset:1024
    buffer_load_dword v191, v2, s[20:23], 0 offen offset:1088
    buffer_load_dword v192, v2, s[20:23], 0 offen offset:2048
    buffer_load_dword v193, v2, s[20:23], 0 offen offset:2112
    buffer_load_dword v194, v2, s[20:23], 0 offen offset:3072
    buffer_load_dword v195, v2, s[20:23], 0 offen offset:3136
    buffer_load_dword v196, v2, s[20:23], s35 offen offset:0
    buffer_load_dword v197, v2, s[20:23], s35 offen offset:64
    buffer_load_dword v198, v2, s[20:23], s35 offen offset:1024
    buffer_load_dword v199, v2, s[20:23], s35 offen offset:1088
    buffer_load_dword v200, v2, s[20:23], s35 offen offset:2048
    buffer_load_dword v201, v2, s[20:23], s35 offen offset:2112
    buffer_load_dword v202, v2, s[20:23], s35 offen offset:3072
    buffer_load_dword v203, v2, s[20:23], s35 offen offset:3136
    v_add_u32 v2, 0x80000, v2
    buffer_load_dword v204, v2, s[20:23], 0 offen offset:0
    buffer_load_dword v205, v2, s[20:23], 0 offen offset:64
    buffer_load_dword v206, v2, s[20:23], 0 offen offset:1024
    buffer_load_dword v207, v2, s[20:23], 0 offen offset:1088
    buffer_load_dword v208, v2, s[20:23], 0 offen offset:2048
    buffer_load_dword v209, v2, s[20:23], 0 offen offset:2112
    buffer_load_dword v210, v2, s[20:23], 0 offen offset:3072
    buffer_load_dword v211, v2, s[20:23], 0 offen offset:3136
    buffer_load_dword v212, v2, s[20:23], s35 offen offset:0
    buffer_load_dword v213, v2, s[20:23], s35 offen offset:64
    buffer_load_dword v214, v2, s[20:23], s35 offen offset:1024
    buffer_load_dword v215, v2, s[20:23], s35 offen offset:1088
    buffer_load_dword v216, v2, s[20:23], s35 offen offset:2048
    buffer_load_dword v217, v2, s[20:23], s35 offen offset:2112
    buffer_load_dword v218, v2, s[20:23], s35 offen offset:3072
    buffer_load_dword v219, v2, s[20:23], s35 offen offset:3136
    v_add_u32 v2, 0x80000, v2
    s_cmp_lg_u32 s31, 3
    s_cbranch_scc1 L_pf3_skip
    s_lshr_b32 s37, s8, 7
    s_sub_u32 s37, 3, s37
    s_and_b32 s37, s37, 7
    s_lshl_b32 s37, s37, 7
    s_lshl_b32 s38, s2, 10
    s_add_u32 s37, s37, s38
    v_lshlrev_b32 v11, 18, v1
    v_add_u32 v11, s37, v11
    buffer_load_dword v11, v11, s[20:23], 0 offen
L_pf3_skip:
    s_waitcnt lgkmcnt(0)
    s_barrier
    ds_read_b128 v[24:27], v3
    ds_read_b128 v[28:31], v3 offset:1024
    s_waitcnt lgkmcnt(1)
    v_mad_u32_u16 v16, v24, s32, v4
    v_mad_u32_u16 v17, v24, s32, v4 op_sel:[1,0,0,0]
    v_mad_u32_u16 v18, v25, s32, v4
    v_mad_u32_u16 v19, v25, s32, v4 op_sel:[1,0,0,0]
    v_mad_u32_u16 v20, v26, s32, v4
    v_mad_u32_u16 v21, v26, s32, v4 op_sel:[1,0,0,0]
    v_mad_u32_u16 v22, v27, s32, v4
    v_mad_u32_u16 v23, v27, s32, v4 op_sel:[1,0,0,0]
    s_waitcnt vmcnt(48)
    s_barrier
    ds_read_b128 a[96:99], v16
    ds_read_b128 a[100:103], v17
    ds_read_b128 a[104:107], v18
    ds_read_b128 a[108:111], v19
    ds_read_b128 a[112:115], v20
    ds_read_b128 a[116:119], v21
    ds_read_b128 a[120:123], v22
    ds_read_b128 a[124:127], v23
    v_perm_b32 v76, v158, v156, s33
    v_perm_b32 v77, v162, v160, s33
    v_perm_b32 v78, v166, v164, s33
    v_perm_b32 v79, v170, v168, s33
    v_perm_b32 v80, v158, v156, s34
    v_perm_b32 v81, v162, v160, s34
    v_perm_b32 v82, v166, v164, s34
    v_perm_b32 v83, v170, v168, s34
    v_perm_b32 v84, v159, v157, s33
    v_perm_b32 v85, v163, v161, s33
    v_perm_b32 v86, v167, v165, s33
    v_perm_b32 v87, v171, v169, s33
    v_perm_b32 v88, v159, v157, s34
    v_perm_b32 v89, v163, v161, s34
    v_perm_b32 v90, v167, v165, s34
    v_perm_b32 v91, v171, v169, s34
    buffer_load_dword v220, v2, s[20:23], 0 offen offset:0
    buffer_load_dword v221, v2, s[20:23], 0 offen offset:64
    buffer_load_dword v222, v2, s[20:23], 0 offen offset:1024
    buffer_load_dword v223, v2, s[20:23], 0 offen offset:1088
    buffer_load_dword v224, v2, s[20:23], 0 offen offset:2048
    buffer_load_dword v225, v2, s[20:23], 0 offen offset:2112
    buffer_load_dword v226, v2, s[20:23], 0 offen offset:3072
    buffer_load_dword v227, v2, s[20:23], 0 offen offset:3136
    buffer_load_dword v228, v2, s[20:23], s35 offen offset:0
    buffer_load_dword v229, v2, s[20:23], s35 offen offset:64
    buffer_load_dword v230, v2, s[20:23], s35 offen offset:1024
    buffer_load_dword v231, v2, s[20:23], s35 offen offset:1088
    buffer_load_dword v232, v2, s[20:23], s35 offen offset:2048
    buffer_load_dword v233, v2, s[20:23], s35 offen offset:2112
    buffer_load_dword v234, v2, s[20:23], s35 offen offset:3072
    buffer_load_dword v235, v2, s[20:23], s35 offen offset:3136
    v_add_u32 v2, 0x80000, v2
    s_mov_b32 s36, 4
    .p2align 6
L_k1_loop:
    s_waitcnt vmcnt(48) lgkmcnt(4)
    v_mfma_f32_16x16x32_bf16 v[44:47], v[76:79], a[96:99], v[44:47]
    ds_read_b128 v[32:35], v3 offset:2048
    buffer_load_dword v156, v2, s[20:23], 0 offen offset:0
    v_mfma_f32_16x16x32_bf16 v[48:51], v[80:83], a[96:99], v[48:51]
    v_mad_u32_u16 v16, v28, s32, v4
    v_perm_b32 v92, v174, v172, s33
    v_mfma_f32_16x16x32_bf16 v[52:55], v[84:87], a[96:99], v[52:55]
    buffer_load_dword v157, v2, s[20:23], 0 offen offset:64
    v_perm_b32 v93, v178, v176, s33
    v_mfma_f32_16x16x32_bf16 v[56:59], v[88:91], a[96:99], v[56:59]
    ds_read_b128 a[96:99], v16
    v_mfma_f32_16x16x32_bf16 v[60:63], v[76:79], a[100:103], v[60:63]
    buffer_load_dword v158, v2, s[20:23], 0 offen offset:1024
    v_mfma_f32_16x16x32_bf16 v[64:67], v[80:83], a[100:103], v[64:67]
    v_mad_u32_u16 v17, v28, s32, v4 op_sel:[1,0,0,0]
    v_perm_b32 v94, v182, v180, s33
    v_mfma_f32_16x16x32_bf16 v[68:71], v[84:87], a[100:103], v[68:71]
    buffer_load_dword v159, v2, s[20:23], 0 offen offset:1088
    v_perm_b32 v95, v186, v184, s33
    v_mfma_f32_16x16x32_bf16 v[72:75], v[88:91], a[100:103], v[72:75]
    ds_read_b128 a[100:103], v17
    v_mfma_f32_16x16x32_bf16 a[0:3], v[76:79], a[104:107], a[0:3]
    buffer_load_dword v160, v2, s[20:23], 0 offen offset:2048
    v_mfma_f32_16x16x32_bf16 a[4:7], v[80:83], a[104:107], a[4:7]
    v_mad_u32_u16 v18, v29, s32, v4
    v_perm_b32 v96, v174, v172, s34
    v_mfma_f32_16x16x32_bf16 a[8:11], v[84:87], a[104:107], a[8:11]
    buffer_load_dword v161, v2, s[20:23], 0 offen offset:2112
    v_perm_b32 v97, v178, v176, s34
    v_mfma_f32_16x16x32_bf16 a[12:15], v[88:91], a[104:107], a[12:15]
    ds_read_b128 a[104:107], v18
    v_mfma_f32_16x16x32_bf16 a[16:19], v[76:79], a[108:111], a[16:19]
    buffer_load_dword v162, v2, s[20:23], 0 offen offset:3072
    v_mfma_f32_16x16x32_bf16 a[20:23], v[80:83], a[108:111], a[20:23]
    v_mad_u32_u16 v19, v29, s32, v4 op_sel:[1,0,0,0]
    v_perm_b32 v98, v182, v180, s34
    v_mfma_f32_16x16x32_bf16 a[24:27], v[84:87], a[108:111], a[24:27]
    buffer_load_dword v163, v2, s[20:23], 0 offen offset:3136
    v_perm_b32 v99, v186, v184, s34
    v_mfma_f32_16x16x32_bf16 a[28:31], v[88:91], a[108:111], a[28:31]
    ds_read_b128 a[108:111], v19
    s_waitcnt lgkmcnt(5)
    v_mfma_f32_16x16x32_bf16 a[32:35], v[76:79], a[112:115], a[32:35]
    buffer_load_dword v164, v2, s[20:23], s35 offen offset:0
    v_mfma_f32_16x16x32_bf16 a[36:39], v[80:83], a[112:115], a[36:39]
    v_mad_u32_u16 v20, v30, s32, v4
    v_perm_b32 v100, v175, v173, s33
    v_mfma_f32_16x16x32_bf16 a[40:43], v[84:87], a[112:115], a[40:43]
    buffer_load_dword v165, v2, s[20:23], s35 offen offset:64
    v_perm_b32 v101, v179, v177, s33
    v_mfma_f32_16x16x32_bf16 a[44:47], v[88:91], a[112:115], a[44:47]
    ds_read_b128 a[112:115], v20
    v_mfma_f32_16x16x32_bf16 a[48:51], v[76:79], a[116:119], a[48:51]
    buffer_load_dword v166, v2, s[20:23], s35 offen offset:1024
    v_mfma_f32_16x16x32_bf16 a[52:55], v[80:83], a[116:119], a[52:55]
    v_mad_u32_u16 v21, v30, s32, v4 op_sel:[1,0,0,0]
    v_perm_b32 v102, v183, v181, s33
    v_mfma_f32_16x16x32_bf16 a[56:59], v[84:87], a[116:119], a[56:59]
    buffer_load_dword v167, v2, s[20:23], s35 offen offset:1088
    v_perm_b32 v103, v187, v185, s33
    v_mfma_f32_16x16x32_bf16 a[60:63], v[88:91], a[116:119], a[60:63]
    ds_read_b128 a[116:119], v21
    v_mfma_f32_16x16x32_bf16 a[64:67], v[76:79], a[120:123], a[64:67]
    buffer_load_dword v168, v2, s[20:23], s35 offen offset:2048
    v_mfma_f32_16x16x32_bf16 a[68:71], v[80:83], a[120:123], a[68:71]
    v_mad_u32_u16 v22, v31, s32, v4
    v_perm_b32 v104, v175, v173, s34
    v_mfma_f32_16x16x32_bf16 a[72:75], v[84:87], a[120:123], a[72:75]
    buffer_load_dword v169, v2, s[20:23], s35 offen offset:2112
    v_perm_b32 v105, v179, v177, s34
    v_mfma_f32_16x16x32_bf16 a[76:79], v[88:91], a[120:123], a[76:79]
    ds_read_b128 a[120:123], v22
    v_mfma_f32_16x16x32_bf16 a[80:83], v[76:79], a[124:127], a[80:83]
    buffer_load_dword v170, v2, s[20:23], s35 offen offset:3072
    v_mfma_f32_16x16x32_bf16 a[84:87], v[80:83], a[124:127], a[84:87]
    v_mad_u32_u16 v23, v31, s32, v4 op_sel:[1,0,0,0]
    v_perm_b32 v106, v183, v181, s34
    v_mfma_f32_16x16x32_bf16 a[88:91], v[84:87], a[124:127], a[88:91]
    buffer_load_dword v171, v2, s[20:23], s35 offen offset:3136
    v_perm_b32 v107, v187, v185, s34
    v_mfma_f32_16x16x32_bf16 a[92:95], v[88:91], a[124:127], a[92:95]
    ds_read_b128 a[124:127], v23
    v_add_u32 v2, 0x80000, v2
    s_waitcnt vmcnt(48) lgkmcnt(4)
    v_mfma_f32_16x16x32_bf16 v[44:47], v[92:95], a[96:99], v[44:47]
    ds_read_b128 v[36:39], v3 offset:3072
    buffer_load_dword v172, v2, s[20:23], 0 offen offset:0
    v_mfma_f32_16x16x32_bf16 v[48:51], v[96:99], a[96:99], v[48:51]
    v_mad_u32_u16 v16, v32, s32, v4
    v_perm_b32 v108, v190, v188, s33
    v_mfma_f32_16x16x32_bf16 v[52:55], v[100:103], a[96:99], v[52:55]
    buffer_load_dword v173, v2, s[20:23], 0 offen offset:64
    v_perm_b32 v109, v194, v192, s33
    v_mfma_f32_16x16x32_bf16 v[56:59], v[104:107], a[96:99], v[56:59]
    ds_read_b128 a[96:99], v16
    v_mfma_f32_16x16x32_bf16 v[60:63], v[92:95], a[100:103], v[60:63]
    buffer_load_dword v174, v2, s[20:23], 0 offen offset:1024
    v_mfma_f32_16x16x32_bf16 v[64:67], v[96:99], a[100:103], v[64:67]
    v_mad_u32_u16 v17, v32, s32, v4 op_sel:[1,0,0,0]
    v_perm_b32 v110, v198, v196, s33
    v_mfma_f32_16x16x32_bf16 v[68:71], v[100:103], a[100:103], v[68:71]
    buffer_load_dword v175, v2, s[20:23], 0 offen offset:1088
    v_perm_b32 v111, v202, v200, s33
    v_mfma_f32_16x16x32_bf16 v[72:75], v[104:107], a[100:103], v[72:75]
    ds_read_b128 a[100:103], v17
    v_mfma_f32_16x16x32_bf16 a[0:3], v[92:95], a[104:107], a[0:3]
    buffer_load_dword v176, v2, s[20:23], 0 offen offset:2048
    v_mfma_f32_16x16x32_bf16 a[4:7], v[96:99], a[104:107], a[4:7]
    v_mad_u32_u16 v18, v33, s32, v4
    v_perm_b32 v112, v190, v188, s34
    v_mfma_f32_16x16x32_bf16 a[8:11], v[100:103], a[104:107], a[8:11]
    buffer_load_dword v177, v2, s[20:23], 0 offen offset:2112
    v_perm_b32 v113, v194, v192, s34
    v_mfma_f32_16x16x32_bf16 a[12:15], v[104:107], a[104:107], a[12:15]
    ds_read_b128 a[104:107], v18
    v_mfma_f32_16x16x32_bf16 a[16:19], v[92:95], a[108:111], a[16:19]
    buffer_load_dword v178, v2, s[20:23], 0 offen offset:3072
    v_mfma_f32_16x16x32_bf16 a[20:23], v[96:99], a[108:111], a[20:23]
    v_mad_u32_u16 v19, v33, s32, v4 op_sel:[1,0,0,0]
    v_perm_b32 v114, v198, v196, s34
    v_mfma_f32_16x16x32_bf16 a[24:27], v[100:103], a[108:111], a[24:27]
    buffer_load_dword v179, v2, s[20:23], 0 offen offset:3136
    v_perm_b32 v115, v202, v200, s34
    v_mfma_f32_16x16x32_bf16 a[28:31], v[104:107], a[108:111], a[28:31]
    ds_read_b128 a[108:111], v19
    s_waitcnt lgkmcnt(5)
    v_mfma_f32_16x16x32_bf16 a[32:35], v[92:95], a[112:115], a[32:35]
    buffer_load_dword v180, v2, s[20:23], s35 offen offset:0
    v_mfma_f32_16x16x32_bf16 a[36:39], v[96:99], a[112:115], a[36:39]
    v_mad_u32_u16 v20, v34, s32, v4
    v_perm_b32 v116, v191, v189, s33
    v_mfma_f32_16x16x32_bf16 a[40:43], v[100:103], a[112:115], a[40:43]
    buffer_load_dword v181, v2, s[20:23], s35 offen offset:64
    v_perm_b32 v117, v195, v193, s33
    v_mfma_f32_16x16x32_bf16 a[44:47], v[104:107], a[112:115], a[44:47]
    ds_read_b128 a[112:115], v20
    v_mfma_f32_16x16x32_bf16 a[48:51], v[92:95], a[116:119], a[48:51]
    buffer_load_dword v182, v2, s[20:23], s35 offen offset:1024
    v_mfma_f32_16x16x32_bf16 a[52:55], v[96:99], a[116:119], a[52:55]
    v_mad_u32_u16 v21, v34, s32, v4 op_sel:[1,0,0,0]
    v_perm_b32 v118, v199, v197, s33
    v_mfma_f32_16x16x32_bf16 a[56:59], v[100:103], a[116:119], a[56:59]
    buffer_load_dword v183, v2, s[20:23], s35 offen offset:1088
    v_perm_b32 v119, v203, v201, s33
    v_mfma_f32_16x16x32_bf16 a[60:63], v[104:107], a[116:119], a[60:63]
    ds_read_b128 a[116:119], v21
    v_mfma_f32_16x16x32_bf16 a[64:67], v[92:95], a[120:123], a[64:67]
    buffer_load_dword v184, v2, s[20:23], s35 offen offset:2048
    v_mfma_f32_16x16x32_bf16 a[68:71], v[96:99], a[120:123], a[68:71]
    v_mad_u32_u16 v22, v35, s32, v4
    v_perm_b32 v120, v191, v189, s34
    v_mfma_f32_16x16x32_bf16 a[72:75], v[100:103], a[120:123], a[72:75]
    buffer_load_dword v185, v2, s[20:23], s35 offen offset:2112
    v_perm_b32 v121, v195, v193, s34
    v_mfma_f32_16x16x32_bf16 a[76:79], v[104:107], a[120:123], a[76:79]
    ds_read_b128 a[120:123], v22
    v_mfma_f32_16x16x32_bf16 a[80:83], v[92:95], a[124:127], a[80:83]
    buffer_load_dword v186, v2, s[20:23], s35 offen offset:3072
    v_mfma_f32_16x16x32_bf16 a[84:87], v[96:99], a[124:127], a[84:87]
    v_mad_u32_u16 v23, v35, s32, v4 op_sel:[1,0,0,0]
    v_perm_b32 v122, v199, v197, s34
    v_mfma_f32_16x16x32_bf16 a[88:91], v[100:103], a[124:127], a[88:91]
    buffer_load_dword v187, v2, s[20:23], s35 offen offset:3136
    v_perm_b32 v123, v203, v201, s34
    v_mfma_f32_16x16x32_bf16 a[92:95], v[104:107], a[124:127], a[92:95]
    ds_read_b128 a[124:127], v23
    v_add_u32 v2, 0x80000, v2
    s_waitcnt vmcnt(48) lgkmcnt(4)
    v_mfma_f32_16x16x32_bf16 v[44:47], v[108:111], a[96:99], v[44:47]
    ds_read_b128 v[40:43], v3 offset:4096
    buffer_load_dword v188, v2, s[20:23], 0 offen offset:0
    v_mfma_f32_16x16x32_bf16 v[48:51], v[112:115], a[96:99], v[48:51]
    v_mad_u32_u16 v16, v36, s32, v4
    v_perm_b32 v124, v206, v204, s33
    v_mfma_f32_16x16x32_bf16 v[52:55], v[116:119], a[96:99], v[52:55]
    buffer_load_dword v189, v2, s[20:23], 0 offen offset:64
    v_perm_b32 v125, v210, v208, s33
    v_mfma_f32_16x16x32_bf16 v[56:59], v[120:123], a[96:99], v[56:59]
    ds_read_b128 a[96:99], v16
    v_mfma_f32_16x16x32_bf16 v[60:63], v[108:111], a[100:103], v[60:63]
    buffer_load_dword v190, v2, s[20:23], 0 offen offset:1024
    v_mfma_f32_16x16x32_bf16 v[64:67], v[112:115], a[100:103], v[64:67]
    v_mad_u32_u16 v17, v36, s32, v4 op_sel:[1,0,0,0]
    v_perm_b32 v126, v214, v212, s33
    v_mfma_f32_16x16x32_bf16 v[68:71], v[116:119], a[100:103], v[68:71]
    buffer_load_dword v191, v2, s[20:23], 0 offen offset:1088
    v_perm_b32 v127, v218, v216, s33
    v_mfma_f32_16x16x32_bf16 v[72:75], v[120:123], a[100:103], v[72:75]
    ds_read_b128 a[100:103], v17
    v_mfma_f32_16x16x32_bf16 a[0:3], v[108:111], a[104:107], a[0:3]
    buffer_load_dword v192, v2, s[20:23], 0 offen offset:2048
    v_mfma_f32_16x16x32_bf16 a[4:7], v[112:115], a[104:107], a[4:7]
    v_mad_u32_u16 v18, v37, s32, v4
    v_perm_b32 v128, v206, v204, s34
    v_mfma_f32_16x16x32_bf16 a[8:11], v[116:119], a[104:107], a[8:11]
    buffer_load_dword v193, v2, s[20:23], 0 offen offset:2112
    v_perm_b32 v129, v210, v208, s34
    v_mfma_f32_16x16x32_bf16 a[12:15], v[120:123], a[104:107], a[12:15]
    ds_read_b128 a[104:107], v18
    v_mfma_f32_16x16x32_bf16 a[16:19], v[108:111], a[108:111], a[16:19]
    buffer_load_dword v194, v2, s[20:23], 0 offen offset:3072
    v_mfma_f32_16x16x32_bf16 a[20:23], v[112:115], a[108:111], a[20:23]
    v_mad_u32_u16 v19, v37, s32, v4 op_sel:[1,0,0,0]
    v_perm_b32 v130, v214, v212, s34
    v_mfma_f32_16x16x32_bf16 a[24:27], v[116:119], a[108:111], a[24:27]
    buffer_load_dword v195, v2, s[20:23], 0 offen offset:3136
    v_perm_b32 v131, v218, v216, s34
    v_mfma_f32_16x16x32_bf16 a[28:31], v[120:123], a[108:111], a[28:31]
    ds_read_b128 a[108:111], v19
    s_waitcnt lgkmcnt(5)
    v_mfma_f32_16x16x32_bf16 a[32:35], v[108:111], a[112:115], a[32:35]
    buffer_load_dword v196, v2, s[20:23], s35 offen offset:0
    v_mfma_f32_16x16x32_bf16 a[36:39], v[112:115], a[112:115], a[36:39]
    v_mad_u32_u16 v20, v38, s32, v4
    v_perm_b32 v132, v207, v205, s33
    v_mfma_f32_16x16x32_bf16 a[40:43], v[116:119], a[112:115], a[40:43]
    buffer_load_dword v197, v2, s[20:23], s35 offen offset:64
    v_perm_b32 v133, v211, v209, s33
    v_mfma_f32_16x16x32_bf16 a[44:47], v[120:123], a[112:115], a[44:47]
    ds_read_b128 a[112:115], v20
    v_mfma_f32_16x16x32_bf16 a[48:51], v[108:111], a[116:119], a[48:51]
    buffer_load_dword v198, v2, s[20:23], s35 offen offset:1024
    v_mfma_f32_16x16x32_bf16 a[52:55], v[112:115], a[116:119], a[52:55]
    v_mad_u32_u16 v21, v38, s32, v4 op_sel:[1,0,0,0]
    v_perm_b32 v134, v215, v213, s33
    v_mfma_f32_16x16x32_bf16 a[56:59], v[116:119], a[116:119], a[56:59]
    buffer_load_dword v199, v2, s[20:23], s35 offen offset:1088
    v_perm_b32 v135, v219, v217, s33
    v_mfma_f32_16x16x32_bf16 a[60:63], v[120:123], a[116:119], a[60:63]
    ds_read_b128 a[116:119], v21
    v_mfma_f32_16x16x32_bf16 a[64:67], v[108:111], a[120:123], a[64:67]
    buffer_load_dword v200, v2, s[20:23], s35 offen offset:2048
    v_mfma_f32_16x16x32_bf16 a[68:71], v[112:115], a[120:123], a[68:71]
    v_mad_u32_u16 v22, v39, s32, v4
    v_perm_b32 v136, v207, v205, s34
    v_mfma_f32_16x16x32_bf16 a[72:75], v[116:119], a[120:123], a[72:75]
    buffer_load_dword v201, v2, s[20:23], s35 offen offset:2112
    v_perm_b32 v137, v211, v209, s34
    v_mfma_f32_16x16x32_bf16 a[76:79], v[120:123], a[120:123], a[76:79]
    ds_read_b128 a[120:123], v22
    v_mfma_f32_16x16x32_bf16 a[80:83], v[108:111], a[124:127], a[80:83]
    buffer_load_dword v202, v2, s[20:23], s35 offen offset:3072
    v_mfma_f32_16x16x32_bf16 a[84:87], v[112:115], a[124:127], a[84:87]
    v_mad_u32_u16 v23, v39, s32, v4 op_sel:[1,0,0,0]
    v_perm_b32 v138, v215, v213, s34
    v_mfma_f32_16x16x32_bf16 a[88:91], v[116:119], a[124:127], a[88:91]
    buffer_load_dword v203, v2, s[20:23], s35 offen offset:3136
    v_perm_b32 v139, v219, v217, s34
    v_mfma_f32_16x16x32_bf16 a[92:95], v[120:123], a[124:127], a[92:95]
    ds_read_b128 a[124:127], v23
    v_add_u32 v2, 0x80000, v2
    s_waitcnt vmcnt(48) lgkmcnt(4)
    v_mfma_f32_16x16x32_bf16 v[44:47], v[124:127], a[96:99], v[44:47]
    ds_read_b128 v[24:27], v3 offset:5120
    buffer_load_dword v204, v2, s[20:23], 0 offen offset:0
    v_mfma_f32_16x16x32_bf16 v[48:51], v[128:131], a[96:99], v[48:51]
    v_mad_u32_u16 v16, v40, s32, v4
    v_perm_b32 v140, v222, v220, s33
    v_mfma_f32_16x16x32_bf16 v[52:55], v[132:135], a[96:99], v[52:55]
    buffer_load_dword v205, v2, s[20:23], 0 offen offset:64
    v_perm_b32 v141, v226, v224, s33
    v_mfma_f32_16x16x32_bf16 v[56:59], v[136:139], a[96:99], v[56:59]
    ds_read_b128 a[96:99], v16
    v_mfma_f32_16x16x32_bf16 v[60:63], v[124:127], a[100:103], v[60:63]
    buffer_load_dword v206, v2, s[20:23], 0 offen offset:1024
    v_mfma_f32_16x16x32_bf16 v[64:67], v[128:131], a[100:103], v[64:67]
    v_mad_u32_u16 v17, v40, s32, v4 op_sel:[1,0,0,0]
    v_perm_b32 v142, v230, v228, s33
    v_mfma_f32_16x16x32_bf16 v[68:71], v[132:135], a[100:103], v[68:71]
    buffer_load_dword v207, v2, s[20:23], 0 offen offset:1088
    v_perm_b32 v143, v234, v232, s33
    v_mfma_f32_16x16x32_bf16 v[72:75], v[136:139], a[100:103], v[72:75]
    ds_read_b128 a[100:103], v17
    v_mfma_f32_16x16x32_bf16 a[0:3], v[124:127], a[104:107], a[0:3]
    buffer_load_dword v208, v2, s[20:23], 0 offen offset:2048
    v_mfma_f32_16x16x32_bf16 a[4:7], v[128:131], a[104:107], a[4:7]
    v_mad_u32_u16 v18, v41, s32, v4
    v_perm_b32 v144, v222, v220, s34
    v_mfma_f32_16x16x32_bf16 a[8:11], v[132:135], a[104:107], a[8:11]
    buffer_load_dword v209, v2, s[20:23], 0 offen offset:2112
    v_perm_b32 v145, v226, v224, s34
    v_mfma_f32_16x16x32_bf16 a[12:15], v[136:139], a[104:107], a[12:15]
    ds_read_b128 a[104:107], v18
    v_mfma_f32_16x16x32_bf16 a[16:19], v[124:127], a[108:111], a[16:19]
    buffer_load_dword v210, v2, s[20:23], 0 offen offset:3072
    v_mfma_f32_16x16x32_bf16 a[20:23], v[128:131], a[108:111], a[20:23]
    v_mad_u32_u16 v19, v41, s32, v4 op_sel:[1,0,0,0]
    v_perm_b32 v146, v230, v228, s34
    v_mfma_f32_16x16x32_bf16 a[24:27], v[132:135], a[108:111], a[24:27]
    buffer_load_dword v211, v2, s[20:23], 0 offen offset:3136
    v_perm_b32 v147, v234, v232, s34
    v_mfma_f32_16x16x32_bf16 a[28:31], v[136:139], a[108:111], a[28:31]
    ds_read_b128 a[108:111], v19
    s_waitcnt lgkmcnt(5)
    v_mfma_f32_16x16x32_bf16 a[32:35], v[124:127], a[112:115], a[32:35]
    buffer_load_dword v212, v2, s[20:23], s35 offen offset:0
    v_mfma_f32_16x16x32_bf16 a[36:39], v[128:131], a[112:115], a[36:39]
    v_mad_u32_u16 v20, v42, s32, v4
    v_perm_b32 v148, v223, v221, s33
    v_mfma_f32_16x16x32_bf16 a[40:43], v[132:135], a[112:115], a[40:43]
    buffer_load_dword v213, v2, s[20:23], s35 offen offset:64
    v_perm_b32 v149, v227, v225, s33
    v_mfma_f32_16x16x32_bf16 a[44:47], v[136:139], a[112:115], a[44:47]
    ds_read_b128 a[112:115], v20
    v_mfma_f32_16x16x32_bf16 a[48:51], v[124:127], a[116:119], a[48:51]
    buffer_load_dword v214, v2, s[20:23], s35 offen offset:1024
    v_mfma_f32_16x16x32_bf16 a[52:55], v[128:131], a[116:119], a[52:55]
    v_mad_u32_u16 v21, v42, s32, v4 op_sel:[1,0,0,0]
    v_perm_b32 v150, v231, v229, s33
    v_mfma_f32_16x16x32_bf16 a[56:59], v[132:135], a[116:119], a[56:59]
    buffer_load_dword v215, v2, s[20:23], s35 offen offset:1088
    v_perm_b32 v151, v235, v233, s33
    v_mfma_f32_16x16x32_bf16 a[60:63], v[136:139], a[116:119], a[60:63]
    ds_read_b128 a[116:119], v21
    v_mfma_f32_16x16x32_bf16 a[64:67], v[124:127], a[120:123], a[64:67]
    buffer_load_dword v216, v2, s[20:23], s35 offen offset:2048
    v_mfma_f32_16x16x32_bf16 a[68:71], v[128:131], a[120:123], a[68:71]
    v_mad_u32_u16 v22, v43, s32, v4
    v_perm_b32 v152, v223, v221, s34
    v_mfma_f32_16x16x32_bf16 a[72:75], v[132:135], a[120:123], a[72:75]
    buffer_load_dword v217, v2, s[20:23], s35 offen offset:2112
    v_perm_b32 v153, v227, v225, s34
    v_mfma_f32_16x16x32_bf16 a[76:79], v[136:139], a[120:123], a[76:79]
    ds_read_b128 a[120:123], v22
    v_mfma_f32_16x16x32_bf16 a[80:83], v[124:127], a[124:127], a[80:83]
    buffer_load_dword v218, v2, s[20:23], s35 offen offset:3072
    v_mfma_f32_16x16x32_bf16 a[84:87], v[128:131], a[124:127], a[84:87]
    v_mad_u32_u16 v23, v43, s32, v4 op_sel:[1,0,0,0]
    v_perm_b32 v154, v231, v229, s34
    v_mfma_f32_16x16x32_bf16 a[88:91], v[132:135], a[124:127], a[88:91]
    buffer_load_dword v219, v2, s[20:23], s35 offen offset:3136
    v_perm_b32 v155, v235, v233, s34
    v_mfma_f32_16x16x32_bf16 a[92:95], v[136:139], a[124:127], a[92:95]
    ds_read_b128 a[124:127], v23
    v_add_u32 v2, 0x80000, v2
    s_waitcnt vmcnt(48) lgkmcnt(4)
    v_mfma_f32_16x16x32_bf16 v[44:47], v[140:143], a[96:99], v[44:47]
    ds_read_b128 v[28:31], v3 offset:6144
    buffer_load_dword v220, v2, s[20:23], 0 offen offset:0
    v_mfma_f32_16x16x32_bf16 v[48:51], v[144:147], a[96:99], v[48:51]
    v_mad_u32_u16 v16, v24, s32, v4
    v_perm_b32 v76, v158, v156, s33
    v_mfma_f32_16x16x32_bf16 v[52:55], v[148:151], a[96:99], v[52:55]
    buffer_load_dword v221, v2, s[20:23], 0 offen offset:64
    v_perm_b32 v77, v162, v160, s33
    v_mfma_f32_16x16x32_bf16 v[56:59], v[152:155], a[96:99], v[56:59]
    ds_read_b128 a[96:99], v16
    v_mfma_f32_16x16x32_bf16 v[60:63], v[140:143], a[100:103], v[60:63]
    buffer_load_dword v222, v2, s[20:23], 0 offen offset:1024
    v_mfma_f32_16x16x32_bf16 v[64:67], v[144:147], a[100:103], v[64:67]
    v_mad_u32_u16 v17, v24, s32, v4 op_sel:[1,0,0,0]
    v_perm_b32 v78, v166, v164, s33
    v_mfma_f32_16x16x32_bf16 v[68:71], v[148:151], a[100:103], v[68:71]
    buffer_load_dword v223, v2, s[20:23], 0 offen offset:1088
    v_perm_b32 v79, v170, v168, s33
    v_mfma_f32_16x16x32_bf16 v[72:75], v[152:155], a[100:103], v[72:75]
    ds_read_b128 a[100:103], v17
    v_mfma_f32_16x16x32_bf16 a[0:3], v[140:143], a[104:107], a[0:3]
    buffer_load_dword v224, v2, s[20:23], 0 offen offset:2048
    v_mfma_f32_16x16x32_bf16 a[4:7], v[144:147], a[104:107], a[4:7]
    v_mad_u32_u16 v18, v25, s32, v4
    v_perm_b32 v80, v158, v156, s34
    v_mfma_f32_16x16x32_bf16 a[8:11], v[148:151], a[104:107], a[8:11]
    buffer_load_dword v225, v2, s[20:23], 0 offen offset:2112
    v_perm_b32 v81, v162, v160, s34
    v_mfma_f32_16x16x32_bf16 a[12:15], v[152:155], a[104:107], a[12:15]
    ds_read_b128 a[104:107], v18
    v_mfma_f32_16x16x32_bf16 a[16:19], v[140:143], a[108:111], a[16:19]
    buffer_load_dword v226, v2, s[20:23], 0 offen offset:3072
    v_mfma_f32_16x16x32_bf16 a[20:23], v[144:147], a[108:111], a[20:23]
    v_mad_u32_u16 v19, v25, s32, v4 op_sel:[1,0,0,0]
    v_perm_b32 v82, v166, v164, s34
    v_mfma_f32_16x16x32_bf16 a[24:27], v[148:151], a[108:111], a[24:27]
    buffer_load_dword v227, v2, s[20:23], 0 offen offset:3136
    v_perm_b32 v83, v170, v168, s34
    v_mfma_f32_16x16x32_bf16 a[28:31], v[152:155], a[108:111], a[28:31]
    ds_read_b128 a[108:111], v19
    s_waitcnt lgkmcnt(5)
    v_mfma_f32_16x16x32_bf16 a[32:35], v[140:143], a[112:115], a[32:35]
    buffer_load_dword v228, v2, s[20:23], s35 offen offset:0
    v_mfma_f32_16x16x32_bf16 a[36:39], v[144:147], a[112:115], a[36:39]
    v_mad_u32_u16 v20, v26, s32, v4
    v_perm_b32 v84, v159, v157, s33
    v_mfma_f32_16x16x32_bf16 a[40:43], v[148:151], a[112:115], a[40:43]
    buffer_load_dword v229, v2, s[20:23], s35 offen offset:64
    v_perm_b32 v85, v163, v161, s33
    v_mfma_f32_16x16x32_bf16 a[44:47], v[152:155], a[112:115], a[44:47]
    ds_read_b128 a[112:115], v20
    v_mfma_f32_16x16x32_bf16 a[48:51], v[140:143], a[116:119], a[48:51]
    buffer_load_dword v230, v2, s[20:23], s35 offen offset:1024
    v_mfma_f32_16x16x32_bf16 a[52:55], v[144:147], a[116:119], a[52:55]
    v_mad_u32_u16 v21, v26, s32, v4 op_sel:[1,0,0,0]
    v_perm_b32 v86, v167, v165, s33
    v_mfma_f32_16x16x32_bf16 a[56:59], v[148:151], a[116:119], a[56:59]
    buffer_load_dword v231, v2, s[20:23], s35 offen offset:1088
    v_perm_b32 v87, v171, v169, s33
    v_mfma_f32_16x16x32_bf16 a[60:63], v[152:155], a[116:119], a[60:63]
    ds_read_b128 a[116:119], v21
    v_mfma_f32_16x16x32_bf16 a[64:67], v[140:143], a[120:123], a[64:67]
    buffer_load_dword v232, v2, s[20:23], s35 offen offset:2048
    v_mfma_f32_16x16x32_bf16 a[68:71], v[144:147], a[120:123], a[68:71]
    v_mad_u32_u16 v22, v27, s32, v4
    v_perm_b32 v88, v159, v157, s34
    v_mfma_f32_16x16x32_bf16 a[72:75], v[148:151], a[120:123], a[72:75]
    buffer_load_dword v233, v2, s[20:23], s35 offen offset:2112
    v_perm_b32 v89, v163, v161, s34
    v_mfma_f32_16x16x32_bf16 a[76:79], v[152:155], a[120:123], a[76:79]
    ds_read_b128 a[120:123], v22
    v_add_u32 v3, 5120, v3
    v_mfma_f32_16x16x32_bf16 a[80:83], v[140:143], a[124:127], a[80:83]
    buffer_load_dword v234, v2, s[20:23], s35 offen offset:3072
    s_sub_u32 s36, s36, 1
    v_mfma_f32_16x16x32_bf16 a[84:87], v[144:147], a[124:127], a[84:87]
    v_mad_u32_u16 v23, v27, s32, v4 op_sel:[1,0,0,0]
    v_perm_b32 v90, v167, v165, s34
    v_mfma_f32_16x16x32_bf16 a[88:91], v[148:151], a[124:127], a[88:91]
    buffer_load_dword v235, v2, s[20:23], s35 offen offset:3136
    v_perm_b32 v91, v171, v169, s34
    v_mfma_f32_16x16x32_bf16 a[92:95], v[152:155], a[124:127], a[92:95]
    ds_read_b128 a[124:127], v23
    v_add_u32 v2, 0x80000, v2
    s_cmp_lg_u32 s36, 0
    s_cbranch_scc1 L_k1_loop
    s_waitcnt vmcnt(48) lgkmcnt(4)
    v_mfma_f32_16x16x32_bf16 v[44:47], v[76:79], a[96:99], v[44:47]
    ds_read_b128 v[32:35], v3 offset:2048
    v_perm_b32 v92, v174, v172, s33
    v_mfma_f32_16x16x32_bf16 v[48:51], v[80:83], a[96:99], v[48:51]
    v_mad_u32_u16 v16, v28, s32, v4
    v_mfma_f32_16x16x32_bf16 v[52:55], v[84:87], a[96:99], v[52:55]
    v_perm_b32 v93, v178, v176, s33
    v_mfma_f32_16x16x32_bf16 v[56:59], v[88:91], a[96:99], v[56:59]
    ds_read_b128 a[96:99], v16
    v_mfma_f32_16x16x32_bf16 v[60:63], v[76:79], a[100:103], v[60:63]
    v_perm_b32 v94, v182, v180, s33
    v_mfma_f32_16x16x32_bf16 v[64:67], v[80:83], a[100:103], v[64:67]
    v_mad_u32_u16 v17, v28, s32, v4 op_sel:[1,0,0,0]
    v_mfma_f32_16x16x32_bf16 v[68:71], v[84:87], a[100:103], v[68:71]
    v_perm_b32 v95, v186, v184, s33
    v_mfma_f32_16x16x32_bf16 v[72:75], v[88:91], a[100:103], v[72:75]
    ds_read_b128 a[100:103], v17
    v_mfma_f32_16x16x32_bf16 a[0:3], v[76:79], a[104:107], a[0:3]
    v_perm_b32 v96, v174, v172, s34
    v_mfma_f32_16x16x32_bf16 a[4:7], v[80:83], a[104:107], a[4:7]
    v_mad_u32_u16 v18, v29, s32, v4
    v_mfma_f32_16x16x32_bf16 a[8:11], v[84:87], a[104:107], a[8:11]
    v_perm_b32 v97, v178, v176, s34
    v_mfma_f32_16x16x32_bf16 a[12:15], v[88:91], a[104:107], a[12:15]
    ds_read_b128 a[104:107], v18
    v_mfma_f32_16x16x32_bf16 a[16:19], v[76:79], a[108:111], a[16:19]
    v_perm_b32 v98, v182, v180, s34
    v_mfma_f32_16x16x32_bf16 a[20:23], v[80:83], a[108:111], a[20:23]
    v_mad_u32_u16 v19, v29, s32, v4 op_sel:[1,0,0,0]
    v_mfma_f32_16x16x32_bf16 a[24:27], v[84:87], a[108:111], a[24:27]
    v_perm_b32 v99, v186, v184, s34
    v_mfma_f32_16x16x32_bf16 a[28:31], v[88:91], a[108:111], a[28:31]
    ds_read_b128 a[108:111], v19
    s_waitcnt lgkmcnt(5)
    v_mfma_f32_16x16x32_bf16 a[32:35], v[76:79], a[112:115], a[32:35]
    v_perm_b32 v100, v175, v173, s33
    v_mfma_f32_16x16x32_bf16 a[36:39], v[80:83], a[112:115], a[36:39]
    v_mad_u32_u16 v20, v30, s32, v4
    v_mfma_f32_16x16x32_bf16 a[40:43], v[84:87], a[112:115], a[40:43]
    v_perm_b32 v101, v179, v177, s33
    v_mfma_f32_16x16x32_bf16 a[44:47], v[88:91], a[112:115], a[44:47]
    ds_read_b128 a[112:115], v20
    v_mfma_f32_16x16x32_bf16 a[48:51], v[76:79], a[116:119], a[48:51]
    v_perm_b32 v102, v183, v181, s33
    v_mfma_f32_16x16x32_bf16 a[52:55], v[80:83], a[116:119], a[52:55]
    v_mad_u32_u16 v21, v30, s32, v4 op_sel:[1,0,0,0]
    v_mfma_f32_16x16x32_bf16 a[56:59], v[84:87], a[116:119], a[56:59]
    v_perm_b32 v103, v187, v185, s33
    v_mfma_f32_16x16x32_bf16 a[60:63], v[88:91], a[116:119], a[60:63]
    ds_read_b128 a[116:119], v21
    v_mfma_f32_16x16x32_bf16 a[64:67], v[76:79], a[120:123], a[64:67]
    v_perm_b32 v104, v175, v173, s34
    v_mfma_f32_16x16x32_bf16 a[68:71], v[80:83], a[120:123], a[68:71]
    v_mad_u32_u16 v22, v31, s32, v4
    v_mfma_f32_16x16x32_bf16 a[72:75], v[84:87], a[120:123], a[72:75]
    v_perm_b32 v105, v179, v177, s34
    v_mfma_f32_16x16x32_bf16 a[76:79], v[88:91], a[120:123], a[76:79]
    ds_read_b128 a[120:123], v22
    v_mfma_f32_16x16x32_bf16 a[80:83], v[76:79], a[124:127], a[80:83]
    v_perm_b32 v106, v183, v181, s34
    v_mfma_f32_16x16x32_bf16 a[84:87], v[80:83], a[124:127], a[84:87]
    v_mad_u32_u16 v23, v31, s32, v4 op_sel:[1,0,0,0]
    v_mfma_f32_16x16x32_bf16 a[88:91], v[84:87], a[124:127], a[88:91]
    v_perm_b32 v107, v187, v185, s34
    v_mfma_f32_16x16x32_bf16 a[92:95], v[88:91], a[124:127], a[92:95]
    ds_read_b128 a[124:127], v23
    s_waitcnt vmcnt(32) lgkmcnt(4)
    v_mfma_f32_16x16x32_bf16 v[44:47], v[92:95], a[96:99], v[44:47]
    ds_read_b128 v[36:39], v3 offset:3072
    v_perm_b32 v108, v190, v188, s33
    v_mfma_f32_16x16x32_bf16 v[48:51], v[96:99], a[96:99], v[48:51]
    v_mad_u32_u16 v16, v32, s32, v4
    v_mfma_f32_16x16x32_bf16 v[52:55], v[100:103], a[96:99], v[52:55]
    v_perm_b32 v109, v194, v192, s33
    v_mfma_f32_16x16x32_bf16 v[56:59], v[104:107], a[96:99], v[56:59]
    ds_read_b128 a[96:99], v16
    v_mfma_f32_16x16x32_bf16 v[60:63], v[92:95], a[100:103], v[60:63]
    v_perm_b32 v110, v198, v196, s33
    v_mfma_f32_16x16x32_bf16 v[64:67], v[96:99], a[100:103], v[64:67]
    v_mad_u32_u16 v17, v32, s32, v4 op_sel:[1,0,0,0]
    v_mfma_f32_16x16x32_bf16 v[68:71], v[100:103], a[100:103], v[68:71]
    v_perm_b32 v111, v202, v200, s33
    v_mfma_f32_16x16x32_bf16 v[72:75], v[104:107], a[100:103], v[72:75]
    ds_read_b128 a[100:103], v17
    v_mfma_f32_16x16x32_bf16 a[0:3], v[92:95], a[104:107], a[0:3]
    v_perm_b32 v112, v190, v188, s34
    v_mfma_f32_16x16x32_bf16 a[4:7], v[96:99], a[104:107], a[4:7]
    v_mad_u32_u16 v18, v33, s32, v4
    v_mfma_f32_16x16x32_bf16 a[8:11], v[100:103], a[104:107], a[8:11]
    v_perm_b32 v113, v194, v192, s34
    v_mfma_f32_16x16x32_bf16 a[12:15], v[104:107], a[104:107], a[12:15]
    ds_read_b128 a[104:107], v18
    v_mfma_f32_16x16x32_bf16 a[16:19], v[92:95], a[108:111], a[16:19]
    v_perm_b32 v114, v198, v196, s34
    v_mfma_f32_16x16x32_bf16 a[20:23], v[96:99], a[108:111], a[20:23]
    v_mad_u32_u16 v19, v33, s32, v4 op_sel:[1,0,0,0]
    v_mfma_f32_16x16x32_bf16 a[24:27], v[100:103], a[108:111], a[24:27]
    v_perm_b32 v115, v202, v200, s34
    v_mfma_f32_16x16x32_bf16 a[28:31], v[104:107], a[108:111], a[28:31]
    ds_read_b128 a[108:111], v19
    s_waitcnt lgkmcnt(5)
    v_mfma_f32_16x16x32_bf16 a[32:35], v[92:95], a[112:115], a[32:35]
    v_perm_b32 v116, v191, v189, s33
    v_mfma_f32_16x16x32_bf16 a[36:39], v[96:99], a[112:115], a[36:39]
    v_mad_u32_u16 v20, v34, s32, v4
    v_mfma_f32_16x16x32_bf16 a[40:43], v[100:103], a[112:115], a[40:43]
    v_perm_b32 v117, v195, v193, s33
    v_mfma_f32_16x16x32_bf16 a[44:47], v[104:107], a[112:115], a[44:47]
    ds_read_b128 a[112:115], v20
    v_mfma_f32_16x16x32_bf16 a[48:51], v[92:95], a[116:119], a[48:51]
    v_perm_b32 v118, v199, v197, s33
    v_mfma_f32_16x16x32_bf16 a[52:55], v[96:99], a[116:119], a[52:55]
    v_mad_u32_u16 v21, v34, s32, v4 op_sel:[1,0,0,0]
    v_mfma_f32_16x16x32_bf16 a[56:59], v[100:103], a[116:119], a[56:59]
    v_perm_b32 v119, v203, v201, s33
    v_mfma_f32_16x16x32_bf16 a[60:63], v[104:107], a[116:119], a[60:63]
    ds_read_b128 a[116:119], v21
    v_mfma_f32_16x16x32_bf16 a[64:67], v[92:95], a[120:123], a[64:67]
    v_perm_b32 v120, v191, v189, s34
    v_mfma_f32_16x16x32_bf16 a[68:71], v[96:99], a[120:123], a[68:71]
    v_mad_u32_u16 v22, v35, s32, v4
    v_mfma_f32_16x16x32_bf16 a[72:75], v[100:103], a[120:123], a[72:75]
    v_perm_b32 v121, v195, v193, s34
    v_mfma_f32_16x16x32_bf16 a[76:79], v[104:107], a[120:123], a[76:79]
    ds_read_b128 a[120:123], v22
    v_mfma_f32_16x16x32_bf16 a[80:83], v[92:95], a[124:127], a[80:83]
    v_perm_b32 v122, v199, v197, s34
    v_mfma_f32_16x16x32_bf16 a[84:87], v[96:99], a[124:127], a[84:87]
    v_mad_u32_u16 v23, v35, s32, v4 op_sel:[1,0,0,0]
    v_mfma_f32_16x16x32_bf16 a[88:91], v[100:103], a[124:127], a[88:91]
    v_perm_b32 v123, v203, v201, s34
    v_mfma_f32_16x16x32_bf16 a[92:95], v[104:107], a[124:127], a[92:95]
    ds_read_b128 a[124:127], v23
    s_waitcnt vmcnt(16) lgkmcnt(4)
    v_mfma_f32_16x16x32_bf16 v[44:47], v[108:111], a[96:99], v[44:47]
    ds_read_b128 v[40:43], v3 offset:4096
    v_perm_b32 v124, v206, v204, s33
    v_mfma_f32_16x16x32_bf16 v[48:51], v[112:115], a[96:99], v[48:51]
    v_mad_u32_u16 v16, v36, s32, v4
    v_mfma_f32_16x16x32_bf16 v[52:55], v[116:119], a[96:99], v[52:55]
    v_perm_b32 v125, v210, v208, s33
    v_mfma_f32_16x16x32_bf16 v[56:59], v[120:123], a[96:99], v[56:59]
    ds_read_b128 a[96:99], v16
    v_mfma_f32_16x16x32_bf16 v[60:63], v[108:111], a[100:103], v[60:63]
    v_perm_b32 v126, v214, v212, s33
    v_mfma_f32_16x16x32_bf16 v[64:67], v[112:115], a[100:103], v[64:67]
    v_mad_u32_u16 v17, v36, s32, v4 op_sel:[1,0,0,0]
    v_mfma_f32_16x16x32_bf16 v[68:71], v[116:119], a[100:103], v[68:71]
    v_perm_b32 v127, v218, v216, s33
    v_mfma_f32_16x16x32_bf16 v[72:75], v[120:123], a[100:103], v[72:75]
    ds_read_b128 a[100:103], v17
    v_mfma_f32_16x16x32_bf16 a[0:3], v[108:111], a[104:107], a[0:3]
    v_perm_b32 v128, v206, v204, s34
    v_mfma_f32_16x16x32_bf16 a[4:7], v[112:115], a[104:107], a[4:7]
    v_mad_u32_u16 v18, v37, s32, v4
    v_mfma_f32_16x16x32_bf16 a[8:11], v[116:119], a[104:107], a[8:11]
    v_perm_b32 v129, v210, v208, s34
    v_mfma_f32_16x16x32_bf16 a[12:15], v[120:123], a[104:107], a[12:15]
    ds_read_b128 a[104:107], v18
    v_mfma_f32_16x16x32_bf16 a[16:19], v[108:111], a[108:111], a[16:19]
    v_perm_b32 v130, v214, v212, s34
    v_mfma_f32_16x16x32_bf16 a[20:23], v[112:115], a[108:111], a[20:23]
    v_mad_u32_u16 v19, v37, s32, v4 op_sel:[1,0,0,0]
    v_mfma_f32_16x16x32_bf16 a[24:27], v[116:119], a[108:111], a[24:27]
    v_perm_b32 v131, v218, v216, s34
    v_mfma_f32_16x16x32_bf16 a[28:31], v[120:123], a[108:111], a[28:31]
    ds_read_b128 a[108:111], v19
    s_waitcnt lgkmcnt(5)
    v_mfma_f32_16x16x32_bf16 a[32:35], v[108:111], a[112:115], a[32:35]
    v_perm_b32 v132, v207, v205, s33
    v_mfma_f32_16x16x32_bf16 a[36:39], v[112:115], a[112:115], a[36:39]
    v_mad_u32_u16 v20, v38, s32, v4
    v_mfma_f32_16x16x32_bf16 a[40:43], v[116:119], a[112:115], a[40:43]
    v_perm_b32 v133, v211, v209, s33
    v_mfma_f32_16x16x32_bf16 a[44:47], v[120:123], a[112:115], a[44:47]
    ds_read_b128 a[112:115], v20
    v_mfma_f32_16x16x32_bf16 a[48:51], v[108:111], a[116:119], a[48:51]
    v_perm_b32 v134, v215, v213, s33
    v_mfma_f32_16x16x32_bf16 a[52:55], v[112:115], a[116:119], a[52:55]
    v_mad_u32_u16 v21, v38, s32, v4 op_sel:[1,0,0,0]
    v_mfma_f32_16x16x32_bf16 a[56:59], v[116:119], a[116:119], a[56:59]
    v_perm_b32 v135, v219, v217, s33
    v_mfma_f32_16x16x32_bf16 a[60:63], v[120:123], a[116:119], a[60:63]
    ds_read_b128 a[116:119], v21
    v_mfma_f32_16x16x32_bf16 a[64:67], v[108:111], a[120:123], a[64:67]
    v_perm_b32 v136, v207, v205, s34
    v_mfma_f32_16x16x32_bf16 a[68:71], v[112:115], a[120:123], a[68:71]
    v_mad_u32_u16 v22, v39, s32, v4
    v_mfma_f32_16x16x32_bf16 a[72:75], v[116:119], a[120:123], a[72:75]
    v_perm_b32 v137, v211, v209, s34
    v_mfma_f32_16x16x32_bf16 a[76:79], v[120:123], a[120:123], a[76:79]
    ds_read_b128 a[120:123], v22
    v_mfma_f32_16x16x32_bf16 a[80:83], v[108:111], a[124:127], a[80:83]
    v_perm_b32 v138, v215, v213, s34
    v_mfma_f32_16x16x32_bf16 a[84:87], v[112:115], a[124:127], a[84:87]
    v_mad_u32_u16 v23, v39, s32, v4 op_sel:[1,0,0,0]
    v_mfma_f32_16x16x32_bf16 a[88:91], v[116:119], a[124:127], a[88:91]
    v_perm_b32 v139, v219, v217, s34
    v_mfma_f32_16x16x32_bf16 a[92:95], v[120:123], a[124:127], a[92:95]
    ds_read_b128 a[124:127], v23
    s_waitcnt vmcnt(0) lgkmcnt(4)
    v_mfma_f32_16x16x32_bf16 v[44:47], v[124:127], a[96:99], v[44:47]
    v_perm_b32 v140, v222, v220, s33
    v_mov_b32 v10, 0
    global_load_dword v176, v10, s[76:77] sc1
    v_mfma_f32_16x16x32_bf16 v[48:51], v[128:131], a[96:99], v[48:51]
    v_mad_u32_u16 v16, v40, s32, v4
    s_mov_b32 s12, s88
    v_mfma_f32_16x16x32_bf16 v[52:55], v[132:135], a[96:99], v[52:55]
    v_perm_b32 v141, v226, v224, s33
    s_and_b32 s13, s89, 0xffff
    v_mfma_f32_16x16x32_bf16 v[56:59], v[136:139], a[96:99], v[56:59]
    ds_read_b128 a[96:99], v16
    s_mov_b32 s14, 1024
    s_mov_b32 s15, 0x20000
    v_mfma_f32_16x16x32_bf16 v[60:63], v[124:127], a[100:103], v[60:63]
    v_perm_b32 v142, v230, v228, s33
    s_mov_b32 s16, s90
    v_mfma_f32_16x16x32_bf16 v[64:67], v[128:131], a[100:103], v[64:67]
    v_mad_u32_u16 v17, v40, s32, v4 op_sel:[1,0,0,0]
    s_and_b32 s17, s91, 0xffff
    v_mfma_f32_16x16x32_bf16 v[68:71], v[132:135], a[100:103], v[68:71]
    v_perm_b32 v143, v234, v232, s33
    s_mov_b32 s18, 1024
    v_mfma_f32_16x16x32_bf16 v[72:75], v[136:139], a[100:103], v[72:75]
    ds_read_b128 a[100:103], v17
    s_mov_b32 s19, 0x20000
    buffer_load_dwordx4 v[24:27], v242, s[12:15], 0 offen
    v_mfma_f32_16x16x32_bf16 a[0:3], v[124:127], a[104:107], a[0:3]
    v_perm_b32 v144, v222, v220, s34
    buffer_load_dwordx4 v[28:31], v242, s[16:19], 0 offen
    v_mfma_f32_16x16x32_bf16 a[4:7], v[128:131], a[104:107], a[4:7]
    v_mad_u32_u16 v18, v41, s32, v4
    s_mov_b32 s20, s80
    v_mfma_f32_16x16x32_bf16 a[8:11], v[132:135], a[104:107], a[8:11]
    v_perm_b32 v145, v226, v224, s34
    s_and_b32 s21, s81, 0xffff
    v_mfma_f32_16x16x32_bf16 a[12:15], v[136:139], a[104:107], a[12:15]
    ds_read_b128 a[104:107], v18
    s_mov_b32 s22, 26624
    s_mov_b32 s23, 0x20000
    v_mfma_f32_16x16x32_bf16 a[16:19], v[124:127], a[108:111], a[16:19]
    v_perm_b32 v146, v230, v228, s34
    buffer_load_ushort v172, v244, s[20:23], 0 offen
    v_mfma_f32_16x16x32_bf16 a[20:23], v[128:131], a[108:111], a[20:23]
    v_mad_u32_u16 v19, v41, s32, v4 op_sel:[1,0,0,0]
    s_mov_b32 s4, s82
    v_mfma_f32_16x16x32_bf16 a[24:27], v[132:135], a[108:111], a[24:27]
    v_perm_b32 v147, v234, v232, s34
    s_and_b32 s5, s83, 0xffff
    v_mfma_f32_16x16x32_bf16 a[28:31], v[136:139], a[108:111], a[28:31]
    ds_read_b128 a[108:111], v19
    s_mov_b32 s6, 26
    s_mov_b32 s7, 0x20000
    s_waitcnt lgkmcnt(4)
    v_mfma_f32_16x16x32_bf16 a[32:35], v[124:127], a[112:115], a[32:35]
    v_perm_b32 v148, v223, v221, s33
    buffer_load_ushort v173, v245, s[4:7], 0 offen
    v_mfma_f32_16x16x32_bf16 a[36:39], v[128:131], a[112:115], a[36:39]
    v_mad_u32_u16 v20, v42, s32, v4
    s_mov_b32 s96, s84
    v_mfma_f32_16x16x32_bf16 a[40:43], v[132:135], a[112:115], a[40:43]
    v_perm_b32 v149, v227, v225, s33
    s_and_b32 s97, s85, 0xffff
    v_mfma_f32_16x16x32_bf16 a[44:47], v[136:139], a[112:115], a[44:47]
    ds_read_b128 a[112:115], v20
    s_mov_b32 s98, 2
    s_mov_b32 s99, 0x20000
    v_mfma_f32_16x16x32_bf16 a[48:51], v[124:127], a[116:119], a[48:51]
    v_perm_b32 v150, v231, v229, s33
    buffer_load_ushort v174, v10, s[96:99], 0 offen
    v_mfma_f32_16x16x32_bf16 a[52:55], v[128:131], a[116:119], a[52:55]
    v_mad_u32_u16 v21, v42, s32, v4 op_sel:[1,0,0,0]
    s_mov_b32 s12, s92
    v_mfma_f32_16x16x32_bf16 a[56:59], v[132:135], a[116:119], a[56:59]
    v_perm_b32 v151, v235, v233, s33
    s_and_b32 s13, s93, 0xffff
    v_mfma_f32_16x16x32_bf16 a[60:63], v[136:139], a[116:119], a[60:63]
    ds_read_b128 a[116:119], v21
    s_mov_b32 s14, 2
    s_mov_b32 s15, 0x20000
    v_mfma_f32_16x16x32_bf16 a[64:67], v[124:127], a[120:123], a[64:67]
    v_perm_b32 v152, v223, v221, s34
    buffer_load_ushort v175, v10, s[12:15], 0 offen
    v_mfma_f32_16x16x32_bf16 a[68:71], v[128:131], a[120:123], a[68:71]
    v_mad_u32_u16 v22, v43, s32, v4
    s_mov_b32 s20, s94
    v_mfma_f32_16x16x32_bf16 a[72:75], v[132:135], a[120:123], a[72:75]
    v_perm_b32 v153, v227, v225, s34
    s_and_b32 s21, s95, 0xffff
    v_mfma_f32_16x16x32_bf16 a[76:79], v[136:139], a[120:123], a[76:79]
    ds_read_b128 a[120:123], v22
    s_mov_b32 s22, 2048
    s_mov_b32 s23, 0x20000
    v_mfma_f32_16x16x32_bf16 a[80:83], v[124:127], a[124:127], a[80:83]
    v_perm_b32 v154, v231, v229, s34
    s_mov_b32 s4, 1048576
    v_mfma_f32_16x16x32_bf16 a[84:87], v[128:131], a[124:127], a[84:87]
    v_mad_u32_u16 v23, v43, s32, v4 op_sel:[1,0,0,0]
    s_mov_b32 s5, 2097152
    v_mfma_f32_16x16x32_bf16 a[88:91], v[132:135], a[124:127], a[88:91]
    v_perm_b32 v155, v235, v233, s34
    s_mov_b32 s6, 3145728
    v_mfma_f32_16x16x32_bf16 a[92:95], v[136:139], a[124:127], a[92:95]
    ds_read_b128 a[124:127], v23
    s_waitcnt lgkmcnt(4)
    v_mfma_f32_16x16x32_bf16 a[0:3], v[140:143], a[104:107], a[0:3]
    v_mfma_f32_16x16x32_bf16 a[4:7], v[144:147], a[104:107], a[4:7]
    s_mov_b32 s34, 0x4000
    v_mfma_f32_16x16x32_bf16 a[8:11], v[148:151], a[104:107], a[8:11]
    s_mov_b32 s78, 0xffff0000
    v_mfma_f32_16x16x32_bf16 a[12:15], v[152:155], a[104:107], a[12:15]
    v_mfma_f32_16x16x32_bf16 a[16:19], v[140:143], a[108:111], a[16:19]
    v_mfma_f32_16x16x32_bf16 a[20:23], v[144:147], a[108:111], a[20:23]
    v_mfma_f32_16x16x32_bf16 a[24:27], v[148:151], a[108:111], a[24:27]
    v_mfma_f32_16x16x32_bf16 a[28:31], v[152:155], a[108:111], a[28:31]
    s_waitcnt lgkmcnt(0)
    v_mfma_f32_16x16x32_bf16 a[32:35], v[140:143], a[112:115], a[32:35]
    v_mfma_f32_16x16x32_bf16 a[36:39], v[144:147], a[112:115], a[36:39]
    v_mfma_f32_16x16x32_bf16 a[40:43], v[148:151], a[112:115], a[40:43]
    v_mfma_f32_16x16x32_bf16 a[44:47], v[152:155], a[112:115], a[44:47]
    v_mfma_f32_16x16x32_bf16 a[48:51], v[140:143], a[116:119], a[48:51]
    ds_write_b128 v236, a[0:3] offset:0
    v_mfma_f32_16x16x32_bf16 a[52:55], v[144:147], a[116:119], a[52:55]
    v_mfma_f32_16x16x32_bf16 a[56:59], v[148:151], a[116:119], a[56:59]
    ds_write_b128 v236, a[4:7] offset:1024
    v_mfma_f32_16x16x32_bf16 a[60:63], v[152:155], a[116:119], a[60:63]
    v_mfma_f32_16x16x32_bf16 a[64:67], v[140:143], a[120:123], a[64:67]
    ds_write_b128 v236, a[8:11] offset:2048
    v_mfma_f32_16x16x32_bf16 a[68:71], v[144:147], a[120:123], a[68:71]
    v_mfma_f32_16x16x32_bf16 a[72:75], v[148:151], a[120:123], a[72:75]
    ds_write_b128 v236, a[12:15] offset:3072
    v_mfma_f32_16x16x32_bf16 a[76:79], v[152:155], a[120:123], a[76:79]
    v_mfma_f32_16x16x32_bf16 a[80:83], v[140:143], a[124:127], a[80:83]
    ds_write_b128 v236, a[16:19] offset:4096
    v_mfma_f32_16x16x32_bf16 a[84:87], v[144:147], a[124:127], a[84:87]
    v_mfma_f32_16x16x32_bf16 a[88:91], v[148:151], a[124:127], a[88:91]
    ds_write_b128 v236, a[20:23] offset:5120
    v_mfma_f32_16x16x32_bf16 a[92:95], v[152:155], a[124:127], a[92:95]
    v_mfma_f32_16x16x32_bf16 v[44:47], v[140:143], a[96:99], v[44:47]
    ds_write_b128 v236, a[24:27] offset:6144
    v_mfma_f32_16x16x32_bf16 v[48:51], v[144:147], a[96:99], v[48:51]
    v_mfma_f32_16x16x32_bf16 v[52:55], v[148:151], a[96:99], v[52:55]
    ds_write_b128 v236, a[28:31] offset:7168
    v_mfma_f32_16x16x32_bf16 v[56:59], v[152:155], a[96:99], v[56:59]
    v_mfma_f32_16x16x32_bf16 v[60:63], v[140:143], a[100:103], v[60:63]
    v_mfma_f32_16x16x32_bf16 v[64:67], v[144:147], a[100:103], v[64:67]
    v_mfma_f32_16x16x32_bf16 v[68:71], v[148:151], a[100:103], v[68:71]
    v_mfma_f32_16x16x32_bf16 v[72:75], v[152:155], a[100:103], v[72:75]
L_k1_done:
    s_barrier
    ds_write_b128 v237, a[32:35] offset:0
    ds_write_b128 v237, a[36:39] offset:1024
    ds_write_b128 v237, a[40:43] offset:2048
    ds_write_b128 v237, a[44:47] offset:3072
    ds_write_b128 v237, a[48:51] offset:4096
    ds_write_b128 v237, a[52:55] offset:5120
    ds_write_b128 v237, a[56:59] offset:6144
    ds_write_b128 v237, a[60:63] offset:7168
    ds_write_b128 v238, a[64:67] offset:0
    ds_write_b128 v238, a[68:71] offset:1024
    ds_write_b128 v238, a[72:75] offset:2048
    ds_write_b128 v238, a[76:79] offset:3072
    ds_write_b128 v238, a[80:83] offset:4096
    ds_write_b128 v238, a[84:87] offset:5120
    ds_write_b128 v238, a[88:91] offset:6144
    ds_write_b128 v238, a[92:95] offset:7168
    s_waitcnt lgkmcnt(0)
    s_barrier
    ds_read_b128 v[76:79], v243 offset:0
    ds_read_b128 v[108:111], v239 offset:0
    ds_read_b128 v[140:143], v239 offset:8192
    ds_read_b128 v[80:83], v243 offset:1024
    ds_read_b128 v[112:115], v239 offset:1024
    ds_read_b128 v[144:147], v239 offset:9216
    ds_read_b128 v[84:87], v243 offset:2048
    ds_read_b128 v[116:119], v239 offset:2048
    ds_read_b128 v[148:151], v239 offset:10240
    ds_read_b128 v[88:91], v243 offset:3072
    ds_read_b128 v[120:123], v239 offset:3072
    ds_read_b128 v[152:155], v239 offset:11264
    ds_read_b128 v[92:95], v243 offset:4096
    ds_read_b128 v[124:127], v239 offset:4096
    ds_read_b128 v[156:159], v239 offset:12288
    ds_read_b128 v[96:99], v243 offset:5120
    ds_read_b128 v[128:131], v239 offset:5120
    ds_read_b128 v[160:163], v239 offset:13312
    ds_read_b128 v[100:103], v243 offset:6144
    ds_read_b128 v[132:135], v239 offset:6144
    ds_read_b128 v[164:167], v239 offset:14336
    ds_read_b128 v[104:107], v243 offset:7168
    ds_read_b128 v[136:139], v239 offset:7168
    ds_read_b128 v[168:171], v239 offset:15360
    s_mov_b32 s36, 200000
    s_waitcnt vmcnt(6)
L_k1_nchk:
    v_readfirstlane_b32 s79, v176
    s_cmp_lg_u32 s79, 0
    s_cbranch_scc1 L_k1_ngo
    global_load_dword v176, v10, s[76:77] sc1
    s_waitcnt vmcnt(0)
    s_sub_u32 s36, s36, 1
    s_cbranch_scc0 L_k1_nchk
L_k1_ngo:
    v_mov_b32 v20, s79
    s_waitcnt lgkmcnt(15)
    v_pk_add_f32 v[44:45], v[44:45], v[76:77]
    v_pk_add_f32 v[44:45], v[44:45], v[108:109]
    v_pk_add_f32 v[44:45], v[44:45], v[140:141]
    v_pk_add_f32 v[46:47], v[46:47], v[78:79]
    v_pk_add_f32 v[46:47], v[46:47], v[110:111]
    v_pk_add_f32 v[46:47], v[46:47], v[142:143]
    s_waitcnt lgkmcnt(15)
    v_pk_add_f32 v[48:49], v[48:49], v[80:81]
    v_pk_add_f32 v[48:49], v[48:49], v[112:113]
    v_pk_add_f32 v[48:49], v[48:49], v[144:145]
    v_pk_add_f32 v[50:51], v[50:51], v[82:83]
    v_pk_add_f32 v[50:51], v[50:51], v[114:115]
    v_pk_add_f32 v[50:51], v[50:51], v[146:147]
    v_cvt_pk_bf16_f32 v44, v44, v45
    v_cvt_pk_bf16_f32 v45, v46, v47
    v_cvt_pk_bf16_f32 v46, v48, v49
    v_cvt_pk_bf16_f32 v47, v50, v51
    buffer_store_dwordx4 v[44:47], v240, s[24:27], 0 offen offset:0 sc1
    s_waitcnt lgkmcnt(15)
    v_pk_add_f32 v[52:53], v[52:53], v[84:85]
    v_pk_add_f32 v[52:53], v[52:53], v[116:117]
    v_pk_add_f32 v[52:53], v[52:53], v[148:149]
    v_pk_add_f32 v[54:55], v[54:55], v[86:87]
    v_pk_add_f32 v[54:55], v[54:55], v[118:119]
    v_pk_add_f32 v[54:55], v[54:55], v[150:151]
    s_waitcnt lgkmcnt(12)
    v_pk_add_f32 v[56:57], v[56:57], v[88:89]
    v_pk_add_f32 v[56:57], v[56:57], v[120:121]
    v_pk_add_f32 v[56:57], v[56:57], v[152:153]
    v_pk_add_f32 v[58:59], v[58:59], v[90:91]
    v_pk_add_f32 v[58:59], v[58:59], v[122:123]
    v_pk_add_f32 v[58:59], v[58:59], v[154:155]
    v_cvt_pk_bf16_f32 v52, v52, v53
    v_cvt_pk_bf16_f32 v53, v54, v55
    v_cvt_pk_bf16_f32 v54, v56, v57
    v_cvt_pk_bf16_f32 v55, v58, v59
    buffer_store_dwordx4 v[52:55], v240, s[24:27], 0 offen offset:1024 sc1
    s_waitcnt lgkmcnt(9)
    v_pk_add_f32 v[60:61], v[60:61], v[92:93]
    v_pk_add_f32 v[60:61], v[60:61], v[124:125]
    v_pk_add_f32 v[60:61], v[60:61], v[156:157]
    v_pk_add_f32 v[62:63], v[62:63], v[94:95]
    v_pk_add_f32 v[62:63], v[62:63], v[126:127]
    v_pk_add_f32 v[62:63], v[62:63], v[158:159]
    s_waitcnt lgkmcnt(6)
    v_pk_add_f32 v[64:65], v[64:65], v[96:97]
    v_pk_add_f32 v[64:65], v[64:65], v[128:129]
    v_pk_add_f32 v[64:65], v[64:65], v[160:161]
    v_pk_add_f32 v[66:67], v[66:67], v[98:99]
    v_pk_add_f32 v[66:67], v[66:67], v[130:131]
    v_pk_add_f32 v[66:67], v[66:67], v[162:163]
    v_cvt_pk_bf16_f32 v60, v60, v61
    v_cvt_pk_bf16_f32 v61, v62, v63
    v_cvt_pk_bf16_f32 v62, v64, v65
    v_cvt_pk_bf16_f32 v63, v66, v67
    buffer_store_dwordx4 v[60:63], v240, s[24:27], s34 offen offset:0 sc1
    s_waitcnt lgkmcnt(3)
    v_pk_add_f32 v[68:69], v[68:69], v[100:101]
    v_pk_add_f32 v[68:69], v[68:69], v[132:133]
    v_pk_add_f32 v[68:69], v[68:69], v[164:165]
    v_pk_add_f32 v[70:71], v[70:71], v[102:103]
    v_pk_add_f32 v[70:71], v[70:71], v[134:135]
    v_pk_add_f32 v[70:71], v[70:71], v[166:167]
    s_waitcnt lgkmcnt(0)
    v_pk_add_f32 v[72:73], v[72:73], v[104:105]
    v_pk_add_f32 v[72:73], v[72:73], v[136:137]
    v_pk_add_f32 v[72:73], v[72:73], v[168:169]
    v_pk_add_f32 v[74:75], v[74:75], v[106:107]
    v_pk_add_f32 v[74:75], v[74:75], v[138:139]
    v_pk_add_f32 v[74:75], v[74:75], v[170:171]
    v_cvt_pk_bf16_f32 v68, v68, v69
    v_cvt_pk_bf16_f32 v69, v70, v71
    v_cvt_pk_bf16_f32 v70, v72, v73
    v_cvt_pk_bf16_f32 v71, v74, v75
    buffer_store_dwordx4 v[68:71], v240, s[24:27], s34 offen offset:1024 sc1
    s_waitcnt vmcnt(4)
    v_lshlrev_b32 v156, 16, v24
    v_lshlrev_b32 v164, 16, v28
    v_lshlrev_b32 v157, 16, v25
    v_lshlrev_b32 v165, 16, v29
    v_lshlrev_b32 v158, 16, v26
    v_lshlrev_b32 v166, 16, v30
    v_lshlrev_b32 v159, 16, v27
    v_lshlrev_b32 v167, 16, v31
    v_and_b32 v160, s78, v24
    v_and_b32 v168, s78, v28
    v_and_b32 v161, s78, v25
    v_and_b32 v169, s78, v29
    v_and_b32 v162, s78, v26
    v_and_b32 v170, s78, v30
    v_and_b32 v163, s78, v27
    v_and_b32 v171, s78, v31
    v_lshlrev_b32 v40, 16, v172
    v_lshlrev_b32 v41, 16, v173
    v_mul_f32 v49, v40, v41
    v_lshlrev_b32 v42, 16, v174
    v_lshlrev_b32 v43, 16, v175
    s_waitcnt vmcnt(0)
    s_barrier
    s_mov_b32 s36, 200000
    s_cmp_lg_u32 s31, 0
    s_cbranch_scc1 L_k1_wait
    s_mov_b64 exec, 65535
    global_store_dword v248, v20, s[10:11] sc1
    s_mov_b64 exec, -1
    global_load_dword v5, v249, s[10:11] sc1
    s_sleep 4
    global_load_dword v6, v249, s[10:11] sc1
    s_sleep 4
    global_load_dword v7, v249, s[10:11] sc1
L_k1_fpoll:
    s_waitcnt vmcnt(2)
    v_cmp_ne_u32 vcc, v5, v20
    s_sub_u32 s36, s36, 1
    s_cbranch_scc1 L_k1_wait
    s_cbranch_vccz L_k1_wait
    global_load_dword v5, v249, s[10:11] sc1
    s_waitcnt vmcnt(2)
    v_cmp_ne_u32 vcc, v6, v20
    s_sub_u32 s36, s36, 1
    s_cbranch_scc1 L_k1_wait
    s_cbranch_vccz L_k1_wait
    global_load_dword v6, v249, s[10:11] sc1
    s_waitcnt vmcnt(2)
    v_cmp_ne_u32 vcc, v7, v20
    s_sub_u32 s36, s36, 1
    s_cbranch_scc1 L_k1_wait
    s_cbranch_vccz L_k1_wait
    global_load_dword v7, v249, s[10:11] sc1
    s_branch L_k1_fpoll
L_k1_wait:
    s_barrier
    buffer_load_dwordx4 v[76:79], v241, s[24:27], 0 offen sc1
    buffer_load_dwordx4 v[80:83], v241, s[24:27], s4 offen sc1
    buffer_load_dwordx4 v[84:87], v241, s[24:27], s5 offen sc1
    buffer_load_dwordx4 v[88:91], v241, s[24:27], s6 offen sc1
    s_waitcnt vmcnt(3)
    v_lshlrev_b32 v92, 16, v76
    v_and_b32 v93, s78, v76
    v_lshlrev_b32 v94, 16, v77
    v_and_b32 v95, s78, v77
    v_lshlrev_b32 v96, 16, v78
    v_and_b32 v97, s78, v78
    v_lshlrev_b32 v98, 16, v79
    v_and_b32 v99, s78, v79
    s_waitcnt vmcnt(2)
    v_lshlrev_b32 v100, 16, v80
    v_and_b32 v101, s78, v80
    v_lshlrev_b32 v102, 16, v81
    v_and_b32 v103, s78, v81
    v_lshlrev_b32 v104, 16, v82
    v_and_b32 v105, s78, v82
    v_lshlrev_b32 v106, 16, v83
    v_and_b32 v107, s78, v83
    s_waitcnt vmcnt(1)
    v_lshlrev_b32 v108, 16, v84
    v_and_b32 v109, s78, v84
    v_lshlrev_b32 v110, 16, v85
    v_and_b32 v111, s78, v85
    v_lshlrev_b32 v112, 16, v86
    v_and_b32 v113, s78, v86
    v_lshlrev_b32 v114, 16, v87
    v_and_b32 v115, s78, v87
    s_waitcnt vmcnt(0)
    v_lshlrev_b32 v116, 16, v88
    v_and_b32 v117, s78, v88
    v_lshlrev_b32 v118, 16, v89
    v_and_b32 v119, s78, v89
    v_lshlrev_b32 v120, 16, v90
    v_and_b32 v121, s78, v90
    v_lshlrev_b32 v122, 16, v91
    v_and_b32 v123, s78, v91
    v_mov_b32 v50, 0
    v_mov_b32 v51, 0
    v_pk_add_f32 v[92:93], v[92:93], v[100:101]
    v_pk_add_f32 v[108:109], v[108:109], v[116:117]
    v_pk_add_f32 v[92:93], v[92:93], v[108:109]
    v_cvt_pk_bf16_f32 v52, v92, v93
    v_lshlrev_b32 v92, 16, v52
    v_and_b32 v93, s78, v52
    v_pk_add_f32 v[92:93], v[92:93], v[156:157]
    v_cvt_pk_bf16_f32 v52, v92, v93
    v_lshlrev_b32 v92, 16, v52
    v_and_b32 v93, s78, v52
    v_max_f32 v92, 0, v92
    v_max_f32 v93, 0, v93
    v_pk_fma_f32 v[50:51], v[92:93], v[164:165], v[50:51]
    v_pk_add_f32 v[94:95], v[94:95], v[102:103]
    v_pk_add_f32 v[110:111], v[110:111], v[118:119]
    v_pk_add_f32 v[94:95], v[94:95], v[110:111]
    v_cvt_pk_bf16_f32 v52, v94, v95
    v_lshlrev_b32 v94, 16, v52
    v_and_b32 v95, s78, v52
    v_pk_add_f32 v[94:95], v[94:95], v[158:159]
    v_cvt_pk_bf16_f32 v52, v94, v95
    v_lshlrev_b32 v94, 16, v52
    v_and_b32 v95, s78, v52
    v_max_f32 v94, 0, v94
    v_max_f32 v95, 0, v95
    v_pk_fma_f32 v[50:51], v[94:95], v[166:167], v[50:51]
    v_pk_add_f32 v[96:97], v[96:97], v[104:105]
    v_pk_add_f32 v[112:113], v[112:113], v[120:121]
    v_pk_add_f32 v[96:97], v[96:97], v[112:113]
    v_cvt_pk_bf16_f32 v52, v96, v97
    v_lshlrev_b32 v96, 16, v52
    v_and_b32 v97, s78, v52
    v_pk_add_f32 v[96:97], v[96:97], v[160:161]
    v_cvt_pk_bf16_f32 v52, v96, v97
    v_lshlrev_b32 v96, 16, v52
    v_and_b32 v97, s78, v52
    v_max_f32 v96, 0, v96
    v_max_f32 v97, 0, v97
    v_pk_fma_f32 v[50:51], v[96:97], v[168:169], v[50:51]
    v_pk_add_f32 v[98:99], v[98:99], v[106:107]
    v_pk_add_f32 v[114:115], v[114:115], v[122:123]
    v_pk_add_f32 v[98:99], v[98:99], v[114:115]
    v_cvt_pk_bf16_f32 v52, v98, v99
    v_lshlrev_b32 v98, 16, v52
    v_and_b32 v99, s78, v52
    v_pk_add_f32 v[98:99], v[98:99], v[162:163]
    v_cvt_pk_bf16_f32 v52, v98, v99
    v_lshlrev_b32 v98, 16, v52
    v_and_b32 v99, s78, v52
    v_max_f32 v98, 0, v98
    v_max_f32 v99, 0, v99
    v_pk_fma_f32 v[50:51], v[98:99], v[170:171], v[50:51]
    v_add_f32 v48, v50, v51
    s_nop 1
    v_add_f32_dpp v48, v48, v48 row_shr:4 row_mask:0xf bank_mask:0xf bound_ctrl:0
    s_nop 1
    v_add_f32_dpp v48, v48, v48 row_shr:8 row_mask:0xf bank_mask:0xf bound_ctrl:0
    s_nop 1
    v_add_f32_dpp v49, v49, v49 row_shr:4 row_mask:0xf bank_mask:0xf bound_ctrl:0
    s_nop 1
    v_add_f32_dpp v49, v49, v49 row_shr:8 row_mask:0xf bank_mask:0xf bound_ctrl:0
    v_and_b32 v55, 15, v1
    v_cmp_le_u32 vcc, 12, v55
    s_and_saveexec_b64 s[40:41], vcc
    ds_write_b32 v246, v48
    ds_write_b32 v246, v49 offset:256
    s_mov_b64 exec, s[40:41]
    s_waitcnt lgkmcnt(0)
    s_barrier
    v_cmp_gt_u32 vcc, 4, v0
    s_and_saveexec_b64 s[40:41], vcc
    s_cbranch_execz L_k1_fin
    ds_read_b128 v[76:79], v247 offset:0
    ds_read_b128 v[80:83], v247 offset:16
    ds_read_b128 v[84:87], v247 offset:32
    ds_read_b128 v[88:91], v247 offset:48
    ds_read_b128 v[92:95], v247 offset:256
    s_waitcnt lgkmcnt(0)
    v_add_f32 v76, v76, v84
    v_add_f32 v77, v77, v85
    v_add_f32 v78, v78, v86
    v_add_f32 v79, v79, v87
    v_add_f32 v80, v80, v88
    v_add_f32 v81, v81, v89
    v_add_f32 v82, v82, v90
    v_add_f32 v83, v83, v91
    v_add_f32 v76, v76, v80
    v_add_f32 v77, v77, v81
    v_add_f32 v78, v78, v82
    v_add_f32 v79, v79, v83
    v_add_f32 v76, v76, v77
    v_add_f32 v78, v78, v79
    v_add_f32 v76, v76, v78
    v_add_f32 v92, v92, v93
    v_add_f32 v94, v94, v95
    v_add_f32 v92, v92, v94
    v_cvt_pk_bf16_f32 v76, v76, v76
    v_lshlrev_b32 v76, 16, v76
    v_cvt_pk_bf16_f32 v92, v92, v92
    v_lshlrev_b32 v92, 16, v92
    v_add_f32 v76, v76, v43
    v_add_f32 v92, v92, v42
    v_cvt_pk_bf16_f32 v76, v76, v76
    v_lshlrev_b32 v76, 16, v76
    v_cvt_pk_bf16_f32 v92, v92, v92
    v_lshlrev_b32 v92, 16, v92
    v_add_f32 v76, v76, v92
    v_cvt_pk_bf16_f32 v76, v76, v76
    v_lshlrev_b32 v76, 16, v76
    v_mul_f32 v76, 0xbfb8aa3b, v76
    v_exp_f32 v76, v76
    s_nop 0
    v_add_f32 v76, 1.0, v76
    v_rcp_f32 v76, v76
    s_nop 0
    v_cvt_pk_bf16_f32 v76, v76, v76
    v_add_u32 v77, s42, v0
    v_lshlrev_b32 v77, 1, v77
    buffer_store_short v76, v77, s[20:23], 0 offen
L_k1_fin:
    s_mov_b64 exec, -1
L_k1_end:
    s_endpgm
.section .rodata,"a"
.p2align 6
.amdhsa_kernel standalone__deep_cross_wide_deep__recsys_kernel
  .amdhsa_next_free_vgpr 380
  .amdhsa_next_free_sgpr 100
  .amdhsa_accum_offset 252
  .amdhsa_group_segment_fixed_size 0
  .amdhsa_kernarg_size 96
  .amdhsa_user_sgpr_count 2
  .amdhsa_user_sgpr_kernarg_segment_ptr 1
  .amdhsa_system_sgpr_workgroup_id_x 1
.end_amdhsa_kernel
```
